```python
import torch

def _softmax(x, axis=-1):
    return torch.softmax(x, dim=axis)
def _gelu(x):
    return torch.nn.functional.gelu(x, approximate="tanh")
def _silu(x):
    return torch.nn.functional.silu(x)
def _sigmoid(x):
    return torch.sigmoid(x)
def _layernorm(x, axis=-1, eps=1e-5):
    m = x.mean(dim=axis, keepdim=True)
    v = x.var(dim=axis, keepdim=True, unbiased=False)
    return (x - m) / torch.sqrt(v + eps)
def _scatter_add(tgt, idx, src, axis=0):
    return tgt.clone().index_add_(axis, idx, src)
def _segment_sum(src, seg, n):
    out = torch.zeros((n,) + src.shape[1:], dtype=src.dtype)
    return out.index_add_(0, seg, src)
def _pad(x, pw):
    flat = tuple(v for pair in reversed(pw) for v in pair)
    return torch.nn.functional.pad(x, flat)

kernel_name = 'concat_heads__mha_block__linear_attn_block__prompt'

def setup_inputs():

    _w = (lambda a: (lambda t: t.to(torch.bfloat16) if t.is_floating_point() else t)(torch.as_tensor(a)))
    def _A_setup():
        B, S, D, H = 1, 2048, 640, 32
        return {
            "x": _w((lambda *s: torch.randn(*s, dtype=torch.bfloat16) * 0.2)(B, S, D)),
            "wqkv": _w((lambda *s: torch.randn(*s, dtype=torch.bfloat16) * 0.2)(D, 3 * D)),
            "wo": _w((lambda *s: torch.randn(*s, dtype=torch.bfloat16) * 0.05)(D, D)),
        }
    _A_in = _A_setup()

    def _B_setup():
        B, S, D = 1, 2048, 640
        return {
            "x": _w((lambda *s: torch.randn(*s, dtype=torch.bfloat16) * 0.05)(B, S, D)),
            "wqkv": _w((lambda *s: torch.randn(*s, dtype=torch.bfloat16) * 1.6)(D, 3 * D)),
            "wo": _w((lambda *s: torch.randn(*s, dtype=torch.bfloat16) * 0.05)(D, D)),
        }
    _B_in = _B_setup()

    return {
        "A_x": _A_in["x"],
        "A_wqkv": _A_in["wqkv"],
        "A_wo": _A_in["wo"],
        "B_x": _B_in["x"],
        "B_wqkv": _B_in["wqkv"],
        "B_wo": _B_in["wo"],
    }

def reference(A_x, A_wqkv, A_wo, B_x, B_wqkv, B_wo):
    def _A_ref(x, wqkv, wo):
        B, S, D = x.shape
        H = 32
        Dh = D // H
        qkv = (lambda x, *d: x.permute(*d))((x @ wqkv).reshape(B, S, 3, H, Dh), 2, 0, 3, 1, 4)
        q, k, v = qkv[0], qkv[1], qkv[2]
        scores = torch.einsum("bhqd,bhkd->bhqk", q, k) * (Dh ** -0.5)
        p = _softmax(scores, axis=-1)
        o = torch.einsum("bhqk,bhkd->bhqd", p, v)
        return (lambda x, *d: x.permute(*d))(o, 0, 2, 1, 3).reshape(B, S, D) @ wo

    def _B_ref(x, wqkv, wo):
        B, S, D = x.shape
        H = 32; Dh = D // H
        qkv = (lambda x, *d: x.permute(*d))((x @ wqkv).reshape(B, S, 3, H, Dh), 2, 0, 3, 1, 4)
        q, k, v = qkv[0], qkv[1], qkv[2]
        phi = lambda t: torch.where(t > 0, t + 1, torch.exp(t)) + 1e-6
        pq, pk = phi(q), phi(k)
        kv = torch.einsum("bhsd,bhse->bhde", pk, v)
        z = torch.einsum("bhsd->bhd", pk)
        num = torch.einsum("bhqd,bhde->bhqe", pq, kv)
        den = torch.einsum("bhqd,bhd->bhq", pq, z)[..., None] + 1e-6
        o = num / den
        return (lambda x, *d: x.permute(*d))(o, 0, 2, 1, 3).reshape(B, S, D) @ wo

    a = _A_ref(A_x, A_wqkv, A_wo)
    b = _B_ref(B_x, B_wqkv, B_wo)
    return torch.concatenate([a, b], axis=-1)
```

```asm
; @launch kernel=concat_heads__mha_block__linear_attn_block__prompt_kernel grid=(256,1,1) block=(512,1,1) lds=163840
.amdgcn_target "amdgcn-amd-amdhsa--gfx950"
.text
.globl concat_heads__mha_block__linear_attn_block__prompt_kernel
.p2align 8
.type concat_heads__mha_block__linear_attn_block__prompt_kernel,@function
concat_heads__mha_block__linear_attn_block__prompt_kernel:
    s_load_dwordx4 s[60:63], s[0:1], 0
    s_load_dwordx4 s[64:67], s[0:1], 24
    s_load_dwordx4 s[88:91], s[0:1], 56
    s_load_dwordx2 s[92:93], s[0:1], 16
    s_load_dwordx4 s[96:99], s[0:1], 40
    s_cmp_ge_u32 s2, 256
    s_cbranch_scc1 k1_exit
    v_lshrrev_b32 v1, 6, v0
    s_and_b32 s17, s2, 7
    s_lshr_b32 s18, s2, 3
    v_readfirstlane_b32 s16, v1
    s_and_b32 s20, s17, 1
    s_lshr_b32 s21, s17, 1
    s_lshr_b32 s19, s18, 4
    s_and_b32 s26, s18, 15
    s_cmp_lg_u32 s19, 0
    s_cselect_b32 s23, 16, 15
    s_mul_i32 s21, s21, s23
    s_cmp_eq_u32 s18, 15
    s_cbranch_scc1 p1_idle
    s_add_u32 s21, s21, s26
    s_and_b32 s22, s21, 3
    s_lshr_b32 s23, s21, 2
k1_dec:
    s_lshl_b32 s20, s20, 2
    s_add_u32 s22, s22, s20
    s_mul_i32 s24, s22, 327680
    s_lshl_b32 s25, s23, 8
    s_mul_i32 s26, s23, 52
    s_lshr_b32 s26, s26, 8
    s_mul_i32 s27, s26, 5
    s_sub_u32 s27, s23, s27
    s_lshl_b32 s27, s27, 7
    s_mov_b32 s47, 0
    s_mov_b32 s70, s23
    s_cmp_eq_u32 s26, 2
    s_cselect_b32 s46, 1, 0
    s_mul_i32 s28, s26, 2752512
    s_cmp_lg_u32 s19, 0
    s_cbranch_scc0 k1_dec2
    s_lshl_b32 s26, s23, 2
    s_mov_b32 s28, 696350288
    s_mov_b32 s29, 4275358522
    s_lshr_b64 s[28:29], s[28:29], s26
    s_and_b32 s23, s28, 15
    s_add_u32 s70, s23, 16
    s_lshl_b32 s25, s23, 8
    s_lshl_b32 s27, s23, 7
    s_mov_b32 s28, 8257536
    s_mov_b32 s46, 0
    s_cmp_lt_u32 s23, 5
    s_cbranch_scc1 k1_dec2
    s_mov_b32 s46, 2
    s_mov_b32 s47, 1152
    s_sub_u32 s23, s23, 5
    s_mul_i32 s25, s23, 120
    s_add_u32 s25, s25, 1280
    s_and_b32 s25, s25, 0xfffffff0
k1_dec2:
    s_mov_b32 s59, s25
    v_and_b32 v1, 63, v0
    v_lshrrev_b32 v3, 4, v1
    v_lshrrev_b32 v2, 3, v1
    v_mul_u32_u24 v2, 1280, v2
    v_and_b32 v4, 7, v1
    v_xor_b32 v4, v4, v3
    v_lshl_add_u32 v8, v4, 4, v2
    v_xor_b32 v9, 64, v8
    v_and_b32 v4, 15, v1
    v_lshlrev_b32 v5, 2, v3
    v_xor_b32 v4, v4, v5
    v_mul_u32_u24 v2, 3840, v3
    v_lshl_add_u32 v10, v4, 4, v2
    v_lshrrev_b32 v4, 3, v4
    v_mul_u32_u24 v4, s47, v4
    v_add_u32 v10, v10, v4
    s_sub_u32 s30, s16, 4
    s_mul_i32 s31, s30, 81920
    s_add_u32 s24, s24, s31
    s_mul_i32 s32, s30, 8192
    s_lshl_b32 s33, s30, 12
    s_add_u32 s33, s33, 32768
    s_mov_b32 s34, 0
    s_mov_b32 s35, 0
    s_mul_i32 s31, s30, 61440
    s_add_u32 s25, s25, s31
    s_lshr_b32 s39, s18, 4
    s_mul_i32 s39, s39, 5
    s_lshl_b32 s40, s17, 2
    s_lshr_b32 s40, 0x27057250, s40
    s_and_b32 s40, s40, 15
    s_add_u32 s39, s39, s40
    s_mul_i32 s40, s39, 205
    s_lshr_b32 s40, s40, 11
    s_mul_i32 s40, s40, 10
    s_sub_u32 s39, s39, s40
    s_mul_i32 s40, s39, 128
    s_add_u32 s24, s24, s40
    s_mul_i32 s40, s39, 245760
    s_add_u32 s25, s25, s40
    s_waitcnt lgkmcnt(0)
    s_cmp_lg_u32 s19, 0
    s_cselect_b32 s60, s64, s60
    s_cselect_b32 s61, s65, s61
    s_cselect_b32 s62, s66, s62
    s_cselect_b32 s63, s67, s63
    s_mov_b32 s4, s60
    s_and_b32 s5, s61, 0xffff
    s_mov_b32 s6, 2621440
    s_mov_b32 s7, 0x20000
    s_mov_b32 s8, s62
    s_and_b32 s9, s63, 0xffff
    s_mov_b32 s10, 2457600
    s_mov_b32 s11, 0x20000
    s_cmp_lt_u32 s16, 4
    s_cbranch_scc1 k1_cons
    s_cmp_eq_u32 s19, 0
    s_cselect_b32 s42, 2, 99
    s_cselect_b32 s43, 99, 2
k1_ld_loop:
    s_add_u32 s36, s35, s32
    s_add_u32 s37, s35, s33
    s_add_u32 m0, s36, 0
    s_add_u32 s38, s24, 0
    buffer_load_dwordx4 v8, s[4:7], s38 offen  lds
    s_add_u32 m0, s36, 1024
    s_add_u32 s38, s24, 10240
    buffer_load_dwordx4 v9, s[4:7], s38 offen  lds
    s_add_u32 m0, s36, 2048
    s_add_u32 s38, s24, 20480
    buffer_load_dwordx4 v8, s[4:7], s38 offen  lds
    s_cmp_lg_u32 s34, 1
    s_cbranch_scc1 k1_ld_w0
    v_mov_b32 v5, 163776
    v_pk_mov_b32 v[6:7], 0, 0
    ds_write_b64 v5, v[6:7]
    s_waitcnt vmcnt(3) lgkmcnt(0)
    s_barrier
k1_ld_w0:
    s_add_u32 m0, s36, 3072
    s_add_u32 s38, s24, 30720
    buffer_load_dwordx4 v9, s[4:7], s38 offen  lds
    s_add_u32 m0, s36, 4096
    s_add_u32 s38, s24, 40960
    buffer_load_dwordx4 v8, s[4:7], s38 offen  lds
    s_add_u32 m0, s36, 5120
    s_add_u32 s38, s24, 51200
    buffer_load_dwordx4 v9, s[4:7], s38 offen  lds
    s_add_u32 m0, s36, 6144
    s_add_u32 s38, s24, 61440
    buffer_load_dwordx4 v8, s[4:7], s38 offen  lds
    s_add_u32 m0, s36, 7168
    s_add_u32 s38, s24, 71680
    buffer_load_dwordx4 v9, s[4:7], s38 offen  lds
    s_cmp_lt_u32 s34, s43
    s_cbranch_scc1 k1_ld_wb
    s_waitcnt vmcnt(8)
    s_barrier
k1_ld_wb:
    s_add_u32 m0, s37, 0
    s_add_u32 s38, s25, 0
    buffer_load_dwordx4 v10, s[8:11], s38 offen  lds
    s_add_u32 m0, s37, 1024
    s_add_u32 s38, s25, 15360
    buffer_load_dwordx4 v10, s[8:11], s38 offen  lds
    s_add_u32 m0, s37, 2048
    s_add_u32 s38, s25, 30720
    buffer_load_dwordx4 v10, s[8:11], s38 offen  lds
    s_add_u32 m0, s37, 3072
    s_add_u32 s38, s25, 46080
    buffer_load_dwordx4 v10, s[8:11], s38 offen  lds
    s_cmp_lt_u32 s34, s42
    s_cbranch_scc1 k1_ld_w
    s_waitcnt vmcnt(12)
    s_barrier
k1_ld_w:
    s_add_u32 s39, s39, 1
    s_cmp_eq_u32 s39, 10
    s_cselect_b32 s40, 1280, 0
    s_cselect_b32 s41, 2457600, 0
    s_sub_u32 s24, s24, s40
    s_sub_u32 s25, s25, s41
    s_add_u32 s24, s24, 128
    s_add_u32 s25, s25, 245760
    s_add_u32 s35, s35, 49152
    s_cmp_eq_u32 s35, 147456
    s_cselect_b32 s35, 0, s35
    s_add_u32 s34, s34, 1
    s_cmp_lt_u32 s34, 10
    s_cbranch_scc1 k1_ld_loop
    s_waitcnt vmcnt(0)
    s_barrier
    s_mov_b32 s12, s90
    s_and_b32 s13, s91, 0xffff
    s_mov_b32 s14, 20971520
    s_mov_b32 s15, 0x20000
    s_branch p2_L
k1_cons:
    s_mov_b32 s12, s90
    s_and_b32 s13, s91, 0xffff
    s_mov_b32 s14, 20971520
    s_mov_b32 s15, 0x20000
    s_nop 0
    s_lshl_b32 s40, s16, 6
    s_mov_b32 s41, 0
    v_and_b32 v1, 63, v0
    v_and_b32 v2, 31, v1
    v_lshrrev_b32 v3, 5, v1
    v_add_u32 v4, s40, v2
    v_lshrrev_b32 v5, 1, v4
    v_and_b32 v5, 7, v5
    v_xor_b32 v5, v5, v3
    v_lshlrev_b32 v4, 7, v4
    v_lshl_add_u32 v16, v5, 4, v4
    v_xor_b32 v17, 32, v16
    v_xor_b32 v18, 64, v16
    v_xor_b32 v19, 0x60, v16
    v_and_b32 v4, 15, v1
    v_lshrrev_b32 v5, 2, v4
    v_lshl_add_u32 v6, v3, 3, v5
    v_lshlrev_b32 v6, 8, v6
    v_bfe_u32 v7, v1, 4, 1
    v_lshlrev_b32 v7, 1, v7
    v_bfe_u32 v8, v1, 1, 1
    v_add_u32 v7, v7, v8
    v_lshlrev_b32 v5, 2, v5
    v_xor_b32 v7, v7, v5
    v_lshl_add_u32 v6, v7, 4, v6
    v_and_b32 v7, 1, v1
    v_lshl_add_u32 v6, v7, 3, v6
    v_add_u32 v6, 32768, v6
    s_lshl_b32 s42, s41, 6
    v_xor_b32 v20, s42, v6
    v_xor_b32 v21, 64, v20
    v_xor_b32 v22, 128, v20
    v_xor_b32 v23, 192, v20
    s_getpc_b64 s[30:31]
pc_c:
    s_sub_u32 s30, s30, pc_c-concat_heads__mha_block__linear_attn_block__prompt_kernel
    s_subb_u32 s31, s31, 0
    s_lshl_b32 s32, s16, 13
    s_add_u32 s30, s30, s32
    s_addc_u32 s31, s31, 0
    v_and_b32 v28, 63, v0
    v_lshlrev_b32 v28, 7, v28
    v_mov_b32 v29, s31
    v_add_co_u32 v28, vcc, s30, v28
    s_nop 1
    v_addc_co_u32 v29, vcc, 0, v29, vcc
    s_mov_b32 s50, 1069066811
    s_mov_b32 s51, 1069066811
    s_mov_b32 s52, 897988541
    s_cmp_lg_u32 s46, 0
    s_cbranch_scc1 k1_F
    s_cmp_eq_u32 s26, 0
    s_cselect_b32 s54, 1051011932, 1.0
    s_mov_b32 s55, s54
    v_and_b32 v1, 31, v0
    v_bfe_u32 v2, v0, 5, 1
    v_add_u32 v1, s40, v1
    v_lshlrev_b32 v1, 4, v1
    v_mul_u32_u24 v2, 32768, v2
    v_add_u32 v1, v1, v2
    s_lshl_b32 s30, s22, 12
    s_mul_i32 s31, s27, 4096
    s_add_u32 s30, s30, s31
    s_add_u32 s30, s30, s28
    v_pk_mov_b32 v[128:129], 0, 0
    v_pk_mov_b32 v[130:131], 0, 0
    v_pk_mov_b32 v[132:133], 0, 0
    v_pk_mov_b32 v[134:135], 0, 0
    v_pk_mov_b32 v[136:137], 0, 0
    v_pk_mov_b32 v[138:139], 0, 0
    v_pk_mov_b32 v[140:141], 0, 0
    v_pk_mov_b32 v[142:143], 0, 0
    v_pk_mov_b32 v[144:145], 0, 0
    v_pk_mov_b32 v[146:147], 0, 0
    v_pk_mov_b32 v[148:149], 0, 0
    v_pk_mov_b32 v[150:151], 0, 0
    v_pk_mov_b32 v[152:153], 0, 0
    v_pk_mov_b32 v[154:155], 0, 0
    v_pk_mov_b32 v[156:157], 0, 0
    v_pk_mov_b32 v[158:159], 0, 0
    v_pk_mov_b32 v[160:161], 0, 0
    v_pk_mov_b32 v[162:163], 0, 0
    v_pk_mov_b32 v[164:165], 0, 0
    v_pk_mov_b32 v[166:167], 0, 0
    v_pk_mov_b32 v[168:169], 0, 0
    v_pk_mov_b32 v[170:171], 0, 0
    v_pk_mov_b32 v[172:173], 0, 0
    v_pk_mov_b32 v[174:175], 0, 0
    v_pk_mov_b32 v[176:177], 0, 0
    v_pk_mov_b32 v[178:179], 0, 0
    v_pk_mov_b32 v[180:181], 0, 0
    v_pk_mov_b32 v[182:183], 0, 0
    v_pk_mov_b32 v[184:185], 0, 0
    v_pk_mov_b32 v[186:187], 0, 0
    v_pk_mov_b32 v[188:189], 0, 0
    v_pk_mov_b32 v[190:191], 0, 0
    v_pk_mov_b32 v[192:193], 0, 0
    v_pk_mov_b32 v[194:195], 0, 0
    v_pk_mov_b32 v[196:197], 0, 0
    v_pk_mov_b32 v[198:199], 0, 0
    v_pk_mov_b32 v[200:201], 0, 0
    v_pk_mov_b32 v[202:203], 0, 0
    v_pk_mov_b32 v[204:205], 0, 0
    v_pk_mov_b32 v[206:207], 0, 0
    v_pk_mov_b32 v[208:209], 0, 0
    v_pk_mov_b32 v[210:211], 0, 0
    v_pk_mov_b32 v[212:213], 0, 0
    v_pk_mov_b32 v[214:215], 0, 0
    v_pk_mov_b32 v[216:217], 0, 0
    v_pk_mov_b32 v[218:219], 0, 0
    v_pk_mov_b32 v[220:221], 0, 0
    v_pk_mov_b32 v[222:223], 0, 0
    v_pk_mov_b32 v[224:225], 0, 0
    v_pk_mov_b32 v[226:227], 0, 0
    v_pk_mov_b32 v[228:229], 0, 0
    v_pk_mov_b32 v[230:231], 0, 0
    v_pk_mov_b32 v[232:233], 0, 0
    v_pk_mov_b32 v[234:235], 0, 0
    v_pk_mov_b32 v[236:237], 0, 0
    v_pk_mov_b32 v[238:239], 0, 0
    v_pk_mov_b32 v[240:241], 0, 0
    v_pk_mov_b32 v[242:243], 0, 0
    v_pk_mov_b32 v[244:245], 0, 0
    v_pk_mov_b32 v[246:247], 0, 0
    v_pk_mov_b32 v[248:249], 0, 0
    v_pk_mov_b32 v[250:251], 0, 0
    v_pk_mov_b32 v[252:253], 0, 0
    v_pk_mov_b32 v[254:255], 0, 0
    s_mov_b32 s43, 0
    s_mov_b32 s44, 0
    s_mov_b32 s48, 49152
    s_barrier
    ds_read_b128 v[32:35], v16 offset:0
    ds_read_b128 v[36:39], v16 offset:4096
    ds_read_b64_tr_b16 v[40:41], v20 offset:0
    ds_read_b64_tr_b16 v[42:43], v20 offset:1024
    ds_read_b64_tr_b16 v[44:45], v21 offset:0
    ds_read_b64_tr_b16 v[46:47], v21 offset:1024
    ds_read_b64_tr_b16 v[48:49], v22 offset:0
    ds_read_b64_tr_b16 v[50:51], v22 offset:1024
    ds_read_b64_tr_b16 v[52:53], v23 offset:0
    ds_read_b64_tr_b16 v[54:55], v23 offset:1024
    .p2align 6
k1T_loop:
    s_waitcnt lgkmcnt(0)
    v_mfma_f32_32x32x16_bf16 v[128:143], v[40:43], v[32:35], v[128:143]
    ds_read_b128 v[56:59], v17 offset:0
    ds_read_b128 v[60:63], v17 offset:4096
    ds_read_b64_tr_b16 v[64:65], v20 offset:4096
    v_mfma_f32_32x32x16_bf16 v[192:207], v[40:43], v[36:39], v[192:207]
    ds_read_b64_tr_b16 v[66:67], v20 offset:5120
    ds_read_b64_tr_b16 v[68:69], v21 offset:4096
    ds_read_b64_tr_b16 v[70:71], v21 offset:5120
    v_mfma_f32_32x32x16_bf16 v[144:159], v[44:47], v[32:35], v[144:159]
    ds_read_b64_tr_b16 v[72:73], v22 offset:4096
    ds_read_b64_tr_b16 v[74:75], v22 offset:5120
    ds_read_b64_tr_b16 v[76:77], v23 offset:4096
    v_mfma_f32_32x32x16_bf16 v[208:223], v[44:47], v[36:39], v[208:223]
    ds_read_b64_tr_b16 v[78:79], v23 offset:5120
    v_mfma_f32_32x32x16_bf16 v[160:175], v[48:51], v[32:35], v[160:175]
    v_mfma_f32_32x32x16_bf16 v[224:239], v[48:51], v[36:39], v[224:239]
    v_mfma_f32_32x32x16_bf16 v[176:191], v[52:55], v[32:35], v[176:191]
    v_mfma_f32_32x32x16_bf16 v[240:255], v[52:55], v[36:39], v[240:255]
    s_waitcnt lgkmcnt(0)
    v_mfma_f32_32x32x16_bf16 v[128:143], v[64:67], v[56:59], v[128:143]
    ds_read_b128 v[32:35], v18 offset:0
    ds_read_b128 v[36:39], v18 offset:4096
    ds_read_b64_tr_b16 v[40:41], v20 offset:8192
    v_mfma_f32_32x32x16_bf16 v[192:207], v[64:67], v[60:63], v[192:207]
    ds_read_b64_tr_b16 v[42:43], v20 offset:9216
    ds_read_b64_tr_b16 v[44:45], v21 offset:8192
    ds_read_b64_tr_b16 v[46:47], v21 offset:9216
    v_mfma_f32_32x32x16_bf16 v[144:159], v[68:71], v[56:59], v[144:159]
    ds_read_b64_tr_b16 v[48:49], v22 offset:8192
    ds_read_b64_tr_b16 v[50:51], v22 offset:9216
    ds_read_b64_tr_b16 v[52:53], v23 offset:8192
    v_mfma_f32_32x32x16_bf16 v[208:223], v[68:71], v[60:63], v[208:223]
    ds_read_b64_tr_b16 v[54:55], v23 offset:9216
    v_mfma_f32_32x32x16_bf16 v[160:175], v[72:75], v[56:59], v[160:175]
    v_mfma_f32_32x32x16_bf16 v[224:239], v[72:75], v[60:63], v[224:239]
    s_and_b32 s58, s18, 7
    s_lshl_b32 s58, s58, 4
    s_or_b32 s58, s58, s43
    v_mfma_f32_32x32x16_bf16 v[176:191], v[76:79], v[56:59], v[176:191]
    s_cmp_lg_u32 s58, 1
    s_cbranch_scc1 k1T_noic
    global_load_dword v30, v[28:29], off
k1T_noic:
    v_mfma_f32_32x32x16_bf16 v[240:255], v[76:79], v[60:63], v[240:255]
    s_waitcnt lgkmcnt(0)
    v_mfma_f32_32x32x16_bf16 v[128:143], v[40:43], v[32:35], v[128:143]
    ds_read_b128 v[56:59], v19 offset:0
    ds_read_b128 v[60:63], v19 offset:4096
    ds_read_b64_tr_b16 v[64:65], v20 offset:12288
    v_mfma_f32_32x32x16_bf16 v[192:207], v[40:43], v[36:39], v[192:207]
    ds_read_b64_tr_b16 v[66:67], v20 offset:13312
    ds_read_b64_tr_b16 v[68:69], v21 offset:12288
    ds_read_b64_tr_b16 v[70:71], v21 offset:13312
    v_mfma_f32_32x32x16_bf16 v[144:159], v[44:47], v[32:35], v[144:159]
    ds_read_b64_tr_b16 v[72:73], v22 offset:12288
    ds_read_b64_tr_b16 v[74:75], v22 offset:13312
    ds_read_b64_tr_b16 v[76:77], v23 offset:12288
    v_mfma_f32_32x32x16_bf16 v[208:223], v[44:47], v[36:39], v[208:223]
    ds_read_b64_tr_b16 v[78:79], v23 offset:13312
    v_mfma_f32_32x32x16_bf16 v[160:175], v[48:51], v[32:35], v[160:175]
    v_mfma_f32_32x32x16_bf16 v[224:239], v[48:51], v[36:39], v[224:239]
    v_mfma_f32_32x32x16_bf16 v[176:191], v[52:55], v[32:35], v[176:191]
    v_mfma_f32_32x32x16_bf16 v[240:255], v[52:55], v[36:39], v[240:255]
    s_add_u32 s44, s44, 1
    s_cmp_eq_u32 s44, 3
    s_cselect_b32 s45, 4294868992, s48
    s_cselect_b32 s44, 0, s44
    s_add_u32 s43, s43, 1
    s_waitcnt lgkmcnt(0)
    v_mfma_f32_32x32x16_bf16 v[128:143], v[64:67], v[56:59], v[128:143]
    s_barrier
    v_mfma_f32_32x32x16_bf16 v[192:207], v[64:67], v[60:63], v[192:207]
    v_add_u32 v16, s45, v16
    v_add_u32 v20, s45, v20
    v_add_u32 v21, s45, v21
    v_add_u32 v22, s45, v22
    v_add_u32 v23, s45, v23
    v_mfma_f32_32x32x16_bf16 v[144:159], v[68:71], v[56:59], v[144:159]
    ds_read_b128 v[32:35], v16 offset:0
    ds_read_b128 v[36:39], v16 offset:4096
    ds_read_b64_tr_b16 v[40:41], v20 offset:0
    v_mfma_f32_32x32x16_bf16 v[208:223], v[68:71], v[60:63], v[208:223]
    ds_read_b64_tr_b16 v[42:43], v20 offset:1024
    ds_read_b64_tr_b16 v[44:45], v21 offset:0
    ds_read_b64_tr_b16 v[46:47], v21 offset:1024
    v_mfma_f32_32x32x16_bf16 v[160:175], v[72:75], v[56:59], v[160:175]
    ds_read_b64_tr_b16 v[48:49], v22 offset:0
    ds_read_b64_tr_b16 v[50:51], v22 offset:1024
    ds_read_b64_tr_b16 v[52:53], v23 offset:0
    v_mfma_f32_32x32x16_bf16 v[224:239], v[72:75], v[60:63], v[224:239]
    ds_read_b64_tr_b16 v[54:55], v23 offset:1024
    v_add_u32 v17, s45, v17
    v_add_u32 v18, s45, v18
    v_add_u32 v19, s45, v19
    v_mfma_f32_32x32x16_bf16 v[176:191], v[76:79], v[56:59], v[176:191]
    s_cmp_lt_u32 s43, 9
    v_mfma_f32_32x32x16_bf16 v[240:255], v[76:79], v[60:63], v[240:255]
    s_cbranch_scc1 k1T_loop
    s_cmp_lg_u32 s19, 0
    s_cbranch_scc1 k1_Tphi
    s_waitcnt vmcnt(0) lgkmcnt(0)
    v_mfma_f32_32x32x16_bf16 v[128:143], v[40:43], v[32:35], v[128:143]
    ds_read_b128 v[56:59], v17 offset:0
    ds_read_b128 v[60:63], v17 offset:4096
    ds_read_b64_tr_b16 v[80:81], v20 offset:4096
    v_mfma_f32_32x32x16_bf16 v[192:207], v[40:43], v[36:39], v[192:207]
    ds_read_b64_tr_b16 v[82:83], v20 offset:5120
    ds_read_b128 v[64:67], v18 offset:0
    ds_read_b128 v[68:71], v18 offset:4096
    v_mfma_f32_32x32x16_bf16 v[144:159], v[44:47], v[32:35], v[144:159]
    ds_read_b64_tr_b16 v[84:85], v20 offset:8192
    ds_read_b64_tr_b16 v[86:87], v20 offset:9216
    ds_read_b128 v[72:75], v19 offset:0
    v_mfma_f32_32x32x16_bf16 v[208:223], v[44:47], v[36:39], v[208:223]
    ds_read_b128 v[76:79], v19 offset:4096
    ds_read_b64_tr_b16 v[88:89], v20 offset:12288
    ds_read_b64_tr_b16 v[90:91], v20 offset:13312
    v_mfma_f32_32x32x16_bf16 v[160:175], v[48:51], v[32:35], v[160:175]
    ds_read_b64_tr_b16 v[92:93], v21 offset:4096
    ds_read_b64_tr_b16 v[94:95], v21 offset:5120
    ds_read_b64_tr_b16 v[96:97], v21 offset:8192
    v_mfma_f32_32x32x16_bf16 v[224:239], v[48:51], v[36:39], v[224:239]
    ds_read_b64_tr_b16 v[98:99], v21 offset:9216
    ds_read_b64_tr_b16 v[100:101], v21 offset:12288
    ds_read_b64_tr_b16 v[102:103], v21 offset:13312
    v_mfma_f32_32x32x16_bf16 v[176:191], v[52:55], v[32:35], v[176:191]
    v_mfma_f32_32x32x16_bf16 v[240:255], v[52:55], v[36:39], v[240:255]
    s_waitcnt lgkmcnt(6)
    v_mfma_f32_32x32x16_bf16 v[128:143], v[80:83], v[56:59], v[128:143]
    v_mfma_f32_32x32x16_bf16 v[192:207], v[80:83], v[60:63], v[192:207]
    v_mfma_f32_32x32x16_bf16 v[128:143], v[84:87], v[64:67], v[128:143]
    v_mfma_f32_32x32x16_bf16 v[192:207], v[84:87], v[68:71], v[192:207]
    v_mfma_f32_32x32x16_bf16 v[128:143], v[88:91], v[72:75], v[128:143]
    v_mfma_f32_32x32x16_bf16 v[192:207], v[88:91], v[76:79], v[192:207]
    s_waitcnt lgkmcnt(0)
    v_mfma_f32_32x32x16_bf16 v[144:159], v[92:95], v[56:59], v[144:159]
    ds_read_b64_tr_b16 v[80:81], v22 offset:4096
    ds_read_b64_tr_b16 v[82:83], v22 offset:5120
    ds_read_b64_tr_b16 v[84:85], v22 offset:8192
    ds_read_b64_tr_b16 v[86:87], v22 offset:9216
    ds_read_b64_tr_b16 v[88:89], v22 offset:12288
    ds_read_b64_tr_b16 v[90:91], v22 offset:13312
    s_nop 4
    v_pk_mul_f32 v[128:129], v[128:129], s[54:55]
    v_pk_mul_f32 v[130:131], v[130:131], s[54:55]
    v_pk_mul_f32 v[132:133], v[132:133], s[54:55]
    v_pk_mul_f32 v[134:135], v[134:135], s[54:55]
    v_cvt_pk_bf16_f32 v32, v128, v129
    v_cvt_pk_bf16_f32 v33, v130, v131
    v_cvt_pk_bf16_f32 v34, v132, v133
    v_cvt_pk_bf16_f32 v35, v134, v135
    s_add_u32 s31, s30, 0
    s_nop 0
    v_permlane32_swap_b32 v32, v34
    v_mfma_f32_32x32x16_bf16 v[208:223], v[92:95], v[60:63], v[208:223]
    v_permlane32_swap_b32 v33, v35
    buffer_store_dwordx4 v[32:35], v1, s[12:15], s31 offen offset:0 sc1
    v_pk_mul_f32 v[192:193], v[192:193], s[54:55]
    v_pk_mul_f32 v[194:195], v[194:195], s[54:55]
    v_pk_mul_f32 v[196:197], v[196:197], s[54:55]
    v_pk_mul_f32 v[198:199], v[198:199], s[54:55]
    v_cvt_pk_bf16_f32 v36, v192, v193
    v_cvt_pk_bf16_f32 v37, v194, v195
    v_cvt_pk_bf16_f32 v38, v196, v197
    v_cvt_pk_bf16_f32 v39, v198, v199
    s_add_u32 s31, s30, 0
    v_mfma_f32_32x32x16_bf16 v[144:159], v[96:99], v[64:67], v[144:159]
    s_nop 0
    v_permlane32_swap_b32 v36, v38
    v_permlane32_swap_b32 v37, v39
    buffer_store_dwordx4 v[36:39], v1, s[12:15], s31 offen offset:512 sc1
    v_pk_mul_f32 v[136:137], v[136:137], s[54:55]
    v_pk_mul_f32 v[138:139], v[138:139], s[54:55]
    v_pk_mul_f32 v[140:141], v[140:141], s[54:55]
    v_pk_mul_f32 v[142:143], v[142:143], s[54:55]
    v_cvt_pk_bf16_f32 v40, v136, v137
    v_cvt_pk_bf16_f32 v41, v138, v139
    v_cvt_pk_bf16_f32 v42, v140, v141
    v_mfma_f32_32x32x16_bf16 v[208:223], v[96:99], v[68:71], v[208:223]
    v_cvt_pk_bf16_f32 v43, v142, v143
    s_add_u32 s31, s30, 65536
    s_nop 0
    v_permlane32_swap_b32 v40, v42
    v_permlane32_swap_b32 v41, v43
    buffer_store_dwordx4 v[40:43], v1, s[12:15], s31 offen offset:0 sc1
    v_pk_mul_f32 v[200:201], v[200:201], s[54:55]
    v_pk_mul_f32 v[202:203], v[202:203], s[54:55]
    v_pk_mul_f32 v[204:205], v[204:205], s[54:55]
    v_pk_mul_f32 v[206:207], v[206:207], s[54:55]
    v_cvt_pk_bf16_f32 v44, v200, v201
    v_mfma_f32_32x32x16_bf16 v[144:159], v[100:103], v[72:75], v[144:159]
    v_cvt_pk_bf16_f32 v45, v202, v203
    v_cvt_pk_bf16_f32 v46, v204, v205
    v_cvt_pk_bf16_f32 v47, v206, v207
    s_add_u32 s31, s30, 65536
    s_nop 0
    v_permlane32_swap_b32 v44, v46
    v_permlane32_swap_b32 v45, v47
    buffer_store_dwordx4 v[44:47], v1, s[12:15], s31 offen offset:512 sc1
    v_mfma_f32_32x32x16_bf16 v[208:223], v[100:103], v[76:79], v[208:223]
    s_waitcnt lgkmcnt(0)
    v_mfma_f32_32x32x16_bf16 v[160:175], v[80:83], v[56:59], v[160:175]
    ds_read_b64_tr_b16 v[92:93], v23 offset:4096
    ds_read_b64_tr_b16 v[94:95], v23 offset:5120
    ds_read_b64_tr_b16 v[96:97], v23 offset:8192
    ds_read_b64_tr_b16 v[98:99], v23 offset:9216
    ds_read_b64_tr_b16 v[100:101], v23 offset:12288
    ds_read_b64_tr_b16 v[102:103], v23 offset:13312
    s_nop 4
    v_pk_mul_f32 v[144:145], v[144:145], s[54:55]
    v_pk_mul_f32 v[146:147], v[146:147], s[54:55]
    v_pk_mul_f32 v[148:149], v[148:149], s[54:55]
    v_pk_mul_f32 v[150:151], v[150:151], s[54:55]
    v_cvt_pk_bf16_f32 v48, v144, v145
    v_cvt_pk_bf16_f32 v49, v146, v147
    v_cvt_pk_bf16_f32 v50, v148, v149
    v_cvt_pk_bf16_f32 v51, v150, v151
    s_add_u32 s31, s30, 131072
    s_nop 0
    v_permlane32_swap_b32 v48, v50
    v_mfma_f32_32x32x16_bf16 v[224:239], v[80:83], v[60:63], v[224:239]
    v_permlane32_swap_b32 v49, v51
    buffer_store_dwordx4 v[48:51], v1, s[12:15], s31 offen offset:0 sc1
    v_pk_mul_f32 v[208:209], v[208:209], s[54:55]
    v_pk_mul_f32 v[210:211], v[210:211], s[54:55]
    v_pk_mul_f32 v[212:213], v[212:213], s[54:55]
    v_pk_mul_f32 v[214:215], v[214:215], s[54:55]
    v_cvt_pk_bf16_f32 v52, v208, v209
    v_cvt_pk_bf16_f32 v53, v210, v211
    v_cvt_pk_bf16_f32 v54, v212, v213
    v_cvt_pk_bf16_f32 v55, v214, v215
    s_add_u32 s31, s30, 131072
    v_mfma_f32_32x32x16_bf16 v[160:175], v[84:87], v[64:67], v[160:175]
    s_nop 0
    v_permlane32_swap_b32 v52, v54
    v_permlane32_swap_b32 v53, v55
    buffer_store_dwordx4 v[52:55], v1, s[12:15], s31 offen offset:512 sc1
    v_pk_mul_f32 v[152:153], v[152:153], s[54:55]
    v_pk_mul_f32 v[154:155], v[154:155], s[54:55]
    v_pk_mul_f32 v[156:157], v[156:157], s[54:55]
    v_pk_mul_f32 v[158:159], v[158:159], s[54:55]
    v_cvt_pk_bf16_f32 v32, v152, v153
    v_cvt_pk_bf16_f32 v33, v154, v155
    v_cvt_pk_bf16_f32 v34, v156, v157
    v_mfma_f32_32x32x16_bf16 v[224:239], v[84:87], v[68:71], v[224:239]
    v_cvt_pk_bf16_f32 v35, v158, v159
    s_add_u32 s31, s30, 196608
    s_nop 0
    v_permlane32_swap_b32 v32, v34
    v_permlane32_swap_b32 v33, v35
    buffer_store_dwordx4 v[32:35], v1, s[12:15], s31 offen offset:0 sc1
    v_pk_mul_f32 v[216:217], v[216:217], s[54:55]
    v_pk_mul_f32 v[218:219], v[218:219], s[54:55]
    v_pk_mul_f32 v[220:221], v[220:221], s[54:55]
    v_pk_mul_f32 v[222:223], v[222:223], s[54:55]
    v_cvt_pk_bf16_f32 v36, v216, v217
    v_mfma_f32_32x32x16_bf16 v[160:175], v[88:91], v[72:75], v[160:175]
    v_cvt_pk_bf16_f32 v37, v218, v219
    v_cvt_pk_bf16_f32 v38, v220, v221
    v_cvt_pk_bf16_f32 v39, v222, v223
    s_add_u32 s31, s30, 196608
    s_nop 0
    v_permlane32_swap_b32 v36, v38
    v_permlane32_swap_b32 v37, v39
    buffer_store_dwordx4 v[36:39], v1, s[12:15], s31 offen offset:512 sc1
    v_mfma_f32_32x32x16_bf16 v[224:239], v[88:91], v[76:79], v[224:239]
    s_waitcnt lgkmcnt(0)
    v_mfma_f32_32x32x16_bf16 v[176:191], v[92:95], v[56:59], v[176:191]
    s_nop 10
    v_pk_mul_f32 v[160:161], v[160:161], s[54:55]
    v_pk_mul_f32 v[162:163], v[162:163], s[54:55]
    v_pk_mul_f32 v[164:165], v[164:165], s[54:55]
    v_pk_mul_f32 v[166:167], v[166:167], s[54:55]
    v_cvt_pk_bf16_f32 v40, v160, v161
    v_cvt_pk_bf16_f32 v41, v162, v163
    v_cvt_pk_bf16_f32 v42, v164, v165
    v_cvt_pk_bf16_f32 v43, v166, v167
    s_add_u32 s31, s30, 262144
    s_nop 0
    v_permlane32_swap_b32 v40, v42
    v_mfma_f32_32x32x16_bf16 v[240:255], v[92:95], v[60:63], v[240:255]
    v_permlane32_swap_b32 v41, v43
    buffer_store_dwordx4 v[40:43], v1, s[12:15], s31 offen offset:0 sc1
    v_pk_mul_f32 v[224:225], v[224:225], s[54:55]
    v_pk_mul_f32 v[226:227], v[226:227], s[54:55]
    v_pk_mul_f32 v[228:229], v[228:229], s[54:55]
    v_pk_mul_f32 v[230:231], v[230:231], s[54:55]
    v_cvt_pk_bf16_f32 v44, v224, v225
    v_cvt_pk_bf16_f32 v45, v226, v227
    v_cvt_pk_bf16_f32 v46, v228, v229
    v_cvt_pk_bf16_f32 v47, v230, v231
    s_add_u32 s31, s30, 262144
    v_mfma_f32_32x32x16_bf16 v[176:191], v[96:99], v[64:67], v[176:191]
    s_nop 0
    v_permlane32_swap_b32 v44, v46
    v_permlane32_swap_b32 v45, v47
    buffer_store_dwordx4 v[44:47], v1, s[12:15], s31 offen offset:512 sc1
    v_pk_mul_f32 v[168:169], v[168:169], s[54:55]
    v_pk_mul_f32 v[170:171], v[170:171], s[54:55]
    v_pk_mul_f32 v[172:173], v[172:173], s[54:55]
    v_pk_mul_f32 v[174:175], v[174:175], s[54:55]
    v_cvt_pk_bf16_f32 v48, v168, v169
    v_cvt_pk_bf16_f32 v49, v170, v171
    v_cvt_pk_bf16_f32 v50, v172, v173
    v_mfma_f32_32x32x16_bf16 v[240:255], v[96:99], v[68:71], v[240:255]
    v_cvt_pk_bf16_f32 v51, v174, v175
    s_add_u32 s31, s30, 327680
    s_nop 0
    v_permlane32_swap_b32 v48, v50
    v_permlane32_swap_b32 v49, v51
    buffer_store_dwordx4 v[48:51], v1, s[12:15], s31 offen offset:0 sc1
    v_pk_mul_f32 v[232:233], v[232:233], s[54:55]
    v_pk_mul_f32 v[234:235], v[234:235], s[54:55]
    v_pk_mul_f32 v[236:237], v[236:237], s[54:55]
    v_pk_mul_f32 v[238:239], v[238:239], s[54:55]
    v_cvt_pk_bf16_f32 v52, v232, v233
    v_mfma_f32_32x32x16_bf16 v[176:191], v[100:103], v[72:75], v[176:191]
    v_cvt_pk_bf16_f32 v53, v234, v235
    v_cvt_pk_bf16_f32 v54, v236, v237
    v_cvt_pk_bf16_f32 v55, v238, v239
    s_add_u32 s31, s30, 327680
    s_nop 0
    v_permlane32_swap_b32 v52, v54
    v_permlane32_swap_b32 v53, v55
    buffer_store_dwordx4 v[52:55], v1, s[12:15], s31 offen offset:512 sc1
    v_mfma_f32_32x32x16_bf16 v[240:255], v[100:103], v[76:79], v[240:255]
    s_nop 7
    s_nop 3
    v_pk_mul_f32 v[176:177], v[176:177], s[54:55]
    v_pk_mul_f32 v[178:179], v[178:179], s[54:55]
    v_pk_mul_f32 v[180:181], v[180:181], s[54:55]
    v_pk_mul_f32 v[182:183], v[182:183], s[54:55]
    v_cvt_pk_bf16_f32 v32, v176, v177
    v_cvt_pk_bf16_f32 v33, v178, v179
    v_cvt_pk_bf16_f32 v34, v180, v181
    v_cvt_pk_bf16_f32 v35, v182, v183
    s_add_u32 s31, s30, 393216
    s_nop 0
    v_permlane32_swap_b32 v32, v34
    v_permlane32_swap_b32 v33, v35
    buffer_store_dwordx4 v[32:35], v1, s[12:15], s31 offen offset:0 sc1
    v_pk_mul_f32 v[240:241], v[240:241], s[54:55]
    v_pk_mul_f32 v[242:243], v[242:243], s[54:55]
    v_pk_mul_f32 v[244:245], v[244:245], s[54:55]
    v_pk_mul_f32 v[246:247], v[246:247], s[54:55]
    v_cvt_pk_bf16_f32 v36, v240, v241
    v_cvt_pk_bf16_f32 v37, v242, v243
    v_cvt_pk_bf16_f32 v38, v244, v245
    v_cvt_pk_bf16_f32 v39, v246, v247
    s_add_u32 s31, s30, 393216
    s_nop 0
    v_permlane32_swap_b32 v36, v38
    v_permlane32_swap_b32 v37, v39
    buffer_store_dwordx4 v[36:39], v1, s[12:15], s31 offen offset:512 sc1
    v_pk_mul_f32 v[184:185], v[184:185], s[54:55]
    v_pk_mul_f32 v[186:187], v[186:187], s[54:55]
    v_pk_mul_f32 v[188:189], v[188:189], s[54:55]
    v_pk_mul_f32 v[190:191], v[190:191], s[54:55]
    v_cvt_pk_bf16_f32 v40, v184, v185
    v_cvt_pk_bf16_f32 v41, v186, v187
    v_cvt_pk_bf16_f32 v42, v188, v189
    v_cvt_pk_bf16_f32 v43, v190, v191
    s_add_u32 s31, s30, 458752
    s_nop 0
    v_permlane32_swap_b32 v40, v42
    v_permlane32_swap_b32 v41, v43
    buffer_store_dwordx4 v[40:43], v1, s[12:15], s31 offen offset:0 sc1
    v_pk_mul_f32 v[248:249], v[248:249], s[54:55]
    v_pk_mul_f32 v[250:251], v[250:251], s[54:55]
    v_pk_mul_f32 v[252:253], v[252:253], s[54:55]
    v_pk_mul_f32 v[254:255], v[254:255], s[54:55]
    v_cvt_pk_bf16_f32 v44, v248, v249
    v_cvt_pk_bf16_f32 v45, v250, v251
    v_cvt_pk_bf16_f32 v46, v252, v253
    v_cvt_pk_bf16_f32 v47, v254, v255
    s_add_u32 s31, s30, 458752
    s_nop 0
    v_permlane32_swap_b32 v44, v46
    v_permlane32_swap_b32 v45, v47
    buffer_store_dwordx4 v[44:47], v1, s[12:15], s31 offen offset:512 sc1
    s_branch p2_C
k1_Tphi:
    s_waitcnt vmcnt(0) lgkmcnt(0)
    v_mfma_f32_32x32x16_bf16 v[128:143], v[40:43], v[32:35], v[128:143]
    ds_read_b128 v[56:59], v17 offset:0
    ds_read_b128 v[60:63], v17 offset:4096
    ds_read_b64_tr_b16 v[80:81], v20 offset:4096
    v_mfma_f32_32x32x16_bf16 v[192:207], v[40:43], v[36:39], v[192:207]
    ds_read_b64_tr_b16 v[82:83], v20 offset:5120
    ds_read_b128 v[64:67], v18 offset:0
    ds_read_b128 v[68:71], v18 offset:4096
    v_mfma_f32_32x32x16_bf16 v[144:159], v[44:47], v[32:35], v[144:159]
    ds_read_b64_tr_b16 v[84:85], v20 offset:8192
    ds_read_b64_tr_b16 v[86:87], v20 offset:9216
    ds_read_b128 v[72:75], v19 offset:0
    v_mfma_f32_32x32x16_bf16 v[208:223], v[44:47], v[36:39], v[208:223]
    ds_read_b128 v[76:79], v19 offset:4096
    ds_read_b64_tr_b16 v[88:89], v20 offset:12288
    ds_read_b64_tr_b16 v[90:91], v20 offset:13312
    v_mfma_f32_32x32x16_bf16 v[160:175], v[48:51], v[32:35], v[160:175]
    ds_read_b64_tr_b16 v[92:93], v21 offset:4096
    ds_read_b64_tr_b16 v[94:95], v21 offset:5120
    ds_read_b64_tr_b16 v[96:97], v21 offset:8192
    v_mfma_f32_32x32x16_bf16 v[224:239], v[48:51], v[36:39], v[224:239]
    ds_read_b64_tr_b16 v[98:99], v21 offset:9216
    ds_read_b64_tr_b16 v[100:101], v21 offset:12288
    ds_read_b64_tr_b16 v[102:103], v21 offset:13312
    v_mfma_f32_32x32x16_bf16 v[176:191], v[52:55], v[32:35], v[176:191]
    v_mfma_f32_32x32x16_bf16 v[240:255], v[52:55], v[36:39], v[240:255]
    s_waitcnt lgkmcnt(6)
    v_mfma_f32_32x32x16_bf16 v[128:143], v[80:83], v[56:59], v[128:143]
    v_mfma_f32_32x32x16_bf16 v[192:207], v[80:83], v[60:63], v[192:207]
    v_mfma_f32_32x32x16_bf16 v[128:143], v[84:87], v[64:67], v[128:143]
    v_mfma_f32_32x32x16_bf16 v[192:207], v[84:87], v[68:71], v[192:207]
    v_mfma_f32_32x32x16_bf16 v[128:143], v[88:91], v[72:75], v[128:143]
    v_mfma_f32_32x32x16_bf16 v[192:207], v[88:91], v[76:79], v[192:207]
    s_waitcnt lgkmcnt(0)
    v_mfma_f32_32x32x16_bf16 v[144:159], v[92:95], v[56:59], v[144:159]
    ds_read_b64_tr_b16 v[80:81], v22 offset:4096
    ds_read_b64_tr_b16 v[82:83], v22 offset:5120
    ds_read_b64_tr_b16 v[84:85], v22 offset:8192
    ds_read_b64_tr_b16 v[86:87], v22 offset:9216
    ds_read_b64_tr_b16 v[88:89], v22 offset:12288
    ds_read_b64_tr_b16 v[90:91], v22 offset:13312
    s_nop 4
    v_pk_mul_f32 v[4:5], v[128:129], s[50:51]
    v_pk_mul_f32 v[6:7], v[130:131], s[50:51]
    v_pk_mul_f32 v[8:9], v[132:133], s[50:51]
    v_pk_mul_f32 v[10:11], v[134:135], s[50:51]
    v_exp_f32_e64 v4, v4 clamp
    v_max_f32 v128, s52, v128
    v_exp_f32_e64 v5, v5 clamp
    v_max_f32 v129, s52, v129
    v_exp_f32_e64 v6, v6 clamp
    v_max_f32 v130, s52, v130
    v_exp_f32_e64 v7, v7 clamp
    v_max_f32 v131, s52, v131
    v_exp_f32_e64 v8, v8 clamp
    v_max_f32 v132, s52, v132
    v_exp_f32_e64 v9, v9 clamp
    v_max_f32 v133, s52, v133
    v_exp_f32_e64 v10, v10 clamp
    v_max_f32 v134, s52, v134
    v_exp_f32_e64 v11, v11 clamp
    v_max_f32 v135, s52, v135
    v_pk_add_f32 v[128:129], v[128:129], v[4:5]
    v_pk_add_f32 v[130:131], v[130:131], v[6:7]
    v_pk_add_f32 v[132:133], v[132:133], v[8:9]
    v_pk_add_f32 v[134:135], v[134:135], v[10:11]
    v_cvt_pk_bf16_f32 v32, v128, v129
    v_cvt_pk_bf16_f32 v33, v130, v131
    v_cvt_pk_bf16_f32 v34, v132, v133
    v_mfma_f32_32x32x16_bf16 v[208:223], v[92:95], v[60:63], v[208:223]
    v_cvt_pk_bf16_f32 v35, v134, v135
    s_add_u32 s31, s30, 0
    s_nop 0
    v_permlane32_swap_b32 v32, v34
    v_permlane32_swap_b32 v33, v35
    buffer_store_dwordx4 v[32:35], v1, s[12:15], s31 offen offset:0 sc1
    v_pk_mul_f32 v[4:5], v[192:193], s[50:51]
    v_pk_mul_f32 v[6:7], v[194:195], s[50:51]
    v_pk_mul_f32 v[8:9], v[196:197], s[50:51]
    v_pk_mul_f32 v[10:11], v[198:199], s[50:51]
    v_exp_f32_e64 v4, v4 clamp
    v_max_f32 v192, s52, v192
    v_exp_f32_e64 v5, v5 clamp
    v_max_f32 v193, s52, v193
    v_exp_f32_e64 v6, v6 clamp
    v_max_f32 v194, s52, v194
    v_exp_f32_e64 v7, v7 clamp
    v_max_f32 v195, s52, v195
    v_exp_f32_e64 v8, v8 clamp
    v_max_f32 v196, s52, v196
    v_exp_f32_e64 v9, v9 clamp
    v_max_f32 v197, s52, v197
    v_exp_f32_e64 v10, v10 clamp
    v_max_f32 v198, s52, v198
    v_exp_f32_e64 v11, v11 clamp
    v_max_f32 v199, s52, v199
    v_pk_add_f32 v[192:193], v[192:193], v[4:5]
    v_mfma_f32_32x32x16_bf16 v[144:159], v[96:99], v[64:67], v[144:159]
    v_pk_add_f32 v[194:195], v[194:195], v[6:7]
    v_pk_add_f32 v[196:197], v[196:197], v[8:9]
    v_pk_add_f32 v[198:199], v[198:199], v[10:11]
    v_cvt_pk_bf16_f32 v36, v192, v193
    v_cvt_pk_bf16_f32 v37, v194, v195
    v_cvt_pk_bf16_f32 v38, v196, v197
    v_cvt_pk_bf16_f32 v39, v198, v199
    s_add_u32 s31, s30, 0
    s_nop 0
    v_permlane32_swap_b32 v36, v38
    v_permlane32_swap_b32 v37, v39
    buffer_store_dwordx4 v[36:39], v1, s[12:15], s31 offen offset:512 sc1
    v_pk_mul_f32 v[4:5], v[136:137], s[50:51]
    v_pk_mul_f32 v[6:7], v[138:139], s[50:51]
    v_pk_mul_f32 v[8:9], v[140:141], s[50:51]
    v_pk_mul_f32 v[10:11], v[142:143], s[50:51]
    v_exp_f32_e64 v4, v4 clamp
    v_max_f32 v136, s52, v136
    v_exp_f32_e64 v5, v5 clamp
    v_max_f32 v137, s52, v137
    v_exp_f32_e64 v6, v6 clamp
    v_max_f32 v138, s52, v138
    v_exp_f32_e64 v7, v7 clamp
    v_max_f32 v139, s52, v139
    v_exp_f32_e64 v8, v8 clamp
    v_max_f32 v140, s52, v140
    v_exp_f32_e64 v9, v9 clamp
    v_mfma_f32_32x32x16_bf16 v[208:223], v[96:99], v[68:71], v[208:223]
    v_max_f32 v141, s52, v141
    v_exp_f32_e64 v10, v10 clamp
    v_max_f32 v142, s52, v142
    v_exp_f32_e64 v11, v11 clamp
    v_max_f32 v143, s52, v143
    v_pk_add_f32 v[136:137], v[136:137], v[4:5]
    v_pk_add_f32 v[138:139], v[138:139], v[6:7]
    v_pk_add_f32 v[140:141], v[140:141], v[8:9]
    v_pk_add_f32 v[142:143], v[142:143], v[10:11]
    v_cvt_pk_bf16_f32 v40, v136, v137
    v_cvt_pk_bf16_f32 v41, v138, v139
    v_cvt_pk_bf16_f32 v42, v140, v141
    v_cvt_pk_bf16_f32 v43, v142, v143
    s_add_u32 s31, s30, 65536
    s_nop 0
    v_permlane32_swap_b32 v40, v42
    v_permlane32_swap_b32 v41, v43
    buffer_store_dwordx4 v[40:43], v1, s[12:15], s31 offen offset:0 sc1
    v_pk_mul_f32 v[4:5], v[200:201], s[50:51]
    v_pk_mul_f32 v[6:7], v[202:203], s[50:51]
    v_pk_mul_f32 v[8:9], v[204:205], s[50:51]
    v_pk_mul_f32 v[10:11], v[206:207], s[50:51]
    v_exp_f32_e64 v4, v4 clamp
    v_max_f32 v200, s52, v200
    v_exp_f32_e64 v5, v5 clamp
    v_max_f32 v201, s52, v201
    v_exp_f32_e64 v6, v6 clamp
    v_mfma_f32_32x32x16_bf16 v[144:159], v[100:103], v[72:75], v[144:159]
    v_max_f32 v202, s52, v202
    v_exp_f32_e64 v7, v7 clamp
    v_max_f32 v203, s52, v203
    v_exp_f32_e64 v8, v8 clamp
    v_max_f32 v204, s52, v204
    v_exp_f32_e64 v9, v9 clamp
    v_max_f32 v205, s52, v205
    v_exp_f32_e64 v10, v10 clamp
    v_max_f32 v206, s52, v206
    v_exp_f32_e64 v11, v11 clamp
    v_max_f32 v207, s52, v207
    v_pk_add_f32 v[200:201], v[200:201], v[4:5]
    v_pk_add_f32 v[202:203], v[202:203], v[6:7]
    v_pk_add_f32 v[204:205], v[204:205], v[8:9]
    v_pk_add_f32 v[206:207], v[206:207], v[10:11]
    v_cvt_pk_bf16_f32 v44, v200, v201
    v_cvt_pk_bf16_f32 v45, v202, v203
    v_cvt_pk_bf16_f32 v46, v204, v205
    v_cvt_pk_bf16_f32 v47, v206, v207
    s_add_u32 s31, s30, 65536
    s_nop 0
    v_permlane32_swap_b32 v44, v46
    v_permlane32_swap_b32 v45, v47
    buffer_store_dwordx4 v[44:47], v1, s[12:15], s31 offen offset:512 sc1
    v_mfma_f32_32x32x16_bf16 v[208:223], v[100:103], v[76:79], v[208:223]
    s_waitcnt lgkmcnt(0)
    v_mfma_f32_32x32x16_bf16 v[160:175], v[80:83], v[56:59], v[160:175]
    ds_read_b64_tr_b16 v[92:93], v23 offset:4096
    ds_read_b64_tr_b16 v[94:95], v23 offset:5120
    ds_read_b64_tr_b16 v[96:97], v23 offset:8192
    ds_read_b64_tr_b16 v[98:99], v23 offset:9216
    ds_read_b64_tr_b16 v[100:101], v23 offset:12288
    ds_read_b64_tr_b16 v[102:103], v23 offset:13312
    s_nop 4
    v_pk_mul_f32 v[4:5], v[144:145], s[50:51]
    v_pk_mul_f32 v[6:7], v[146:147], s[50:51]
    v_pk_mul_f32 v[8:9], v[148:149], s[50:51]
    v_pk_mul_f32 v[10:11], v[150:151], s[50:51]
    v_exp_f32_e64 v4, v4 clamp
    v_max_f32 v144, s52, v144
    v_exp_f32_e64 v5, v5 clamp
    v_max_f32 v145, s52, v145
    v_exp_f32_e64 v6, v6 clamp
    v_max_f32 v146, s52, v146
    v_exp_f32_e64 v7, v7 clamp
    v_max_f32 v147, s52, v147
    v_exp_f32_e64 v8, v8 clamp
    v_max_f32 v148, s52, v148
    v_exp_f32_e64 v9, v9 clamp
    v_max_f32 v149, s52, v149
    v_exp_f32_e64 v10, v10 clamp
    v_max_f32 v150, s52, v150
    v_exp_f32_e64 v11, v11 clamp
    v_max_f32 v151, s52, v151
    v_pk_add_f32 v[144:145], v[144:145], v[4:5]
    v_pk_add_f32 v[146:147], v[146:147], v[6:7]
    v_pk_add_f32 v[148:149], v[148:149], v[8:9]
    v_pk_add_f32 v[150:151], v[150:151], v[10:11]
    v_cvt_pk_bf16_f32 v48, v144, v145
    v_cvt_pk_bf16_f32 v49, v146, v147
    v_cvt_pk_bf16_f32 v50, v148, v149
    v_mfma_f32_32x32x16_bf16 v[224:239], v[80:83], v[60:63], v[224:239]
    v_cvt_pk_bf16_f32 v51, v150, v151
    s_add_u32 s31, s30, 131072
    s_nop 0
    v_permlane32_swap_b32 v48, v50
    v_permlane32_swap_b32 v49, v51
    buffer_store_dwordx4 v[48:51], v1, s[12:15], s31 offen offset:0 sc1
    v_pk_mul_f32 v[4:5], v[208:209], s[50:51]
    v_pk_mul_f32 v[6:7], v[210:211], s[50:51]
    v_pk_mul_f32 v[8:9], v[212:213], s[50:51]
    v_pk_mul_f32 v[10:11], v[214:215], s[50:51]
    v_exp_f32_e64 v4, v4 clamp
    v_max_f32 v208, s52, v208
    v_exp_f32_e64 v5, v5 clamp
    v_max_f32 v209, s52, v209
    v_exp_f32_e64 v6, v6 clamp
    v_max_f32 v210, s52, v210
    v_exp_f32_e64 v7, v7 clamp
    v_max_f32 v211, s52, v211
    v_exp_f32_e64 v8, v8 clamp
    v_max_f32 v212, s52, v212
    v_exp_f32_e64 v9, v9 clamp
    v_max_f32 v213, s52, v213
    v_exp_f32_e64 v10, v10 clamp
    v_max_f32 v214, s52, v214
    v_exp_f32_e64 v11, v11 clamp
    v_max_f32 v215, s52, v215
    v_pk_add_f32 v[208:209], v[208:209], v[4:5]
    v_mfma_f32_32x32x16_bf16 v[160:175], v[84:87], v[64:67], v[160:175]
    v_pk_add_f32 v[210:211], v[210:211], v[6:7]
    v_pk_add_f32 v[212:213], v[212:213], v[8:9]
    v_pk_add_f32 v[214:215], v[214:215], v[10:11]
    v_cvt_pk_bf16_f32 v52, v208, v209
    v_cvt_pk_bf16_f32 v53, v210, v211
    v_cvt_pk_bf16_f32 v54, v212, v213
    v_cvt_pk_bf16_f32 v55, v214, v215
    s_add_u32 s31, s30, 131072
    s_nop 0
    v_permlane32_swap_b32 v52, v54
    v_permlane32_swap_b32 v53, v55
    buffer_store_dwordx4 v[52:55], v1, s[12:15], s31 offen offset:512 sc1
    v_pk_mul_f32 v[4:5], v[152:153], s[50:51]
    v_pk_mul_f32 v[6:7], v[154:155], s[50:51]
    v_pk_mul_f32 v[8:9], v[156:157], s[50:51]
    v_pk_mul_f32 v[10:11], v[158:159], s[50:51]
    v_exp_f32_e64 v4, v4 clamp
    v_max_f32 v152, s52, v152
    v_exp_f32_e64 v5, v5 clamp
    v_max_f32 v153, s52, v153
    v_exp_f32_e64 v6, v6 clamp
    v_max_f32 v154, s52, v154
    v_exp_f32_e64 v7, v7 clamp
    v_max_f32 v155, s52, v155
    v_exp_f32_e64 v8, v8 clamp
    v_max_f32 v156, s52, v156
    v_exp_f32_e64 v9, v9 clamp
    v_mfma_f32_32x32x16_bf16 v[224:239], v[84:87], v[68:71], v[224:239]
    v_max_f32 v157, s52, v157
    v_exp_f32_e64 v10, v10 clamp
    v_max_f32 v158, s52, v158
    v_exp_f32_e64 v11, v11 clamp
    v_max_f32 v159, s52, v159
    v_pk_add_f32 v[152:153], v[152:153], v[4:5]
    v_pk_add_f32 v[154:155], v[154:155], v[6:7]
    v_pk_add_f32 v[156:157], v[156:157], v[8:9]
    v_pk_add_f32 v[158:159], v[158:159], v[10:11]
    v_cvt_pk_bf16_f32 v32, v152, v153
    v_cvt_pk_bf16_f32 v33, v154, v155
    v_cvt_pk_bf16_f32 v34, v156, v157
    v_cvt_pk_bf16_f32 v35, v158, v159
    s_add_u32 s31, s30, 196608
    s_nop 0
    v_permlane32_swap_b32 v32, v34
    v_permlane32_swap_b32 v33, v35
    buffer_store_dwordx4 v[32:35], v1, s[12:15], s31 offen offset:0 sc1
    v_pk_mul_f32 v[4:5], v[216:217], s[50:51]
    v_pk_mul_f32 v[6:7], v[218:219], s[50:51]
    v_pk_mul_f32 v[8:9], v[220:221], s[50:51]
    v_pk_mul_f32 v[10:11], v[222:223], s[50:51]
    v_exp_f32_e64 v4, v4 clamp
    v_max_f32 v216, s52, v216
    v_exp_f32_e64 v5, v5 clamp
    v_max_f32 v217, s52, v217
    v_exp_f32_e64 v6, v6 clamp
    v_mfma_f32_32x32x16_bf16 v[160:175], v[88:91], v[72:75], v[160:175]
    v_max_f32 v218, s52, v218
    v_exp_f32_e64 v7, v7 clamp
    v_max_f32 v219, s52, v219
    v_exp_f32_e64 v8, v8 clamp
    v_max_f32 v220, s52, v220
    v_exp_f32_e64 v9, v9 clamp
    v_max_f32 v221, s52, v221
    v_exp_f32_e64 v10, v10 clamp
    v_max_f32 v222, s52, v222
    v_exp_f32_e64 v11, v11 clamp
    v_max_f32 v223, s52, v223
    v_pk_add_f32 v[216:217], v[216:217], v[4:5]
    v_pk_add_f32 v[218:219], v[218:219], v[6:7]
    v_pk_add_f32 v[220:221], v[220:221], v[8:9]
    v_pk_add_f32 v[222:223], v[222:223], v[10:11]
    v_cvt_pk_bf16_f32 v36, v216, v217
    v_cvt_pk_bf16_f32 v37, v218, v219
    v_cvt_pk_bf16_f32 v38, v220, v221
    v_cvt_pk_bf16_f32 v39, v222, v223
    s_add_u32 s31, s30, 196608
    s_nop 0
    v_permlane32_swap_b32 v36, v38
    v_permlane32_swap_b32 v37, v39
    buffer_store_dwordx4 v[36:39], v1, s[12:15], s31 offen offset:512 sc1
    v_mfma_f32_32x32x16_bf16 v[224:239], v[88:91], v[76:79], v[224:239]
    s_waitcnt lgkmcnt(0)
    v_mfma_f32_32x32x16_bf16 v[176:191], v[92:95], v[56:59], v[176:191]
    s_nop 10
    v_pk_mul_f32 v[4:5], v[160:161], s[50:51]
    v_pk_mul_f32 v[6:7], v[162:163], s[50:51]
    v_pk_mul_f32 v[8:9], v[164:165], s[50:51]
    v_pk_mul_f32 v[10:11], v[166:167], s[50:51]
    v_exp_f32_e64 v4, v4 clamp
    v_max_f32 v160, s52, v160
    v_exp_f32_e64 v5, v5 clamp
    v_max_f32 v161, s52, v161
    v_exp_f32_e64 v6, v6 clamp
    v_max_f32 v162, s52, v162
    v_exp_f32_e64 v7, v7 clamp
    v_max_f32 v163, s52, v163
    v_exp_f32_e64 v8, v8 clamp
    v_max_f32 v164, s52, v164
    v_exp_f32_e64 v9, v9 clamp
    v_max_f32 v165, s52, v165
    v_exp_f32_e64 v10, v10 clamp
    v_max_f32 v166, s52, v166
    v_exp_f32_e64 v11, v11 clamp
    v_max_f32 v167, s52, v167
    v_pk_add_f32 v[160:161], v[160:161], v[4:5]
    v_pk_add_f32 v[162:163], v[162:163], v[6:7]
    v_pk_add_f32 v[164:165], v[164:165], v[8:9]
    v_pk_add_f32 v[166:167], v[166:167], v[10:11]
    v_cvt_pk_bf16_f32 v40, v160, v161
    v_cvt_pk_bf16_f32 v41, v162, v163
    v_cvt_pk_bf16_f32 v42, v164, v165
    v_mfma_f32_32x32x16_bf16 v[240:255], v[92:95], v[60:63], v[240:255]
    v_cvt_pk_bf16_f32 v43, v166, v167
    s_add_u32 s31, s30, 262144
    s_nop 0
    v_permlane32_swap_b32 v40, v42
    v_permlane32_swap_b32 v41, v43
    buffer_store_dwordx4 v[40:43], v1, s[12:15], s31 offen offset:0 sc1
    v_pk_mul_f32 v[4:5], v[224:225], s[50:51]
    v_pk_mul_f32 v[6:7], v[226:227], s[50:51]
    v_pk_mul_f32 v[8:9], v[228:229], s[50:51]
    v_pk_mul_f32 v[10:11], v[230:231], s[50:51]
    v_exp_f32_e64 v4, v4 clamp
    v_max_f32 v224, s52, v224
    v_exp_f32_e64 v5, v5 clamp
    v_max_f32 v225, s52, v225
    v_exp_f32_e64 v6, v6 clamp
    v_max_f32 v226, s52, v226
    v_exp_f32_e64 v7, v7 clamp
    v_max_f32 v227, s52, v227
    v_exp_f32_e64 v8, v8 clamp
    v_max_f32 v228, s52, v228
    v_exp_f32_e64 v9, v9 clamp
    v_max_f32 v229, s52, v229
    v_exp_f32_e64 v10, v10 clamp
    v_max_f32 v230, s52, v230
    v_exp_f32_e64 v11, v11 clamp
    v_max_f32 v231, s52, v231
    v_pk_add_f32 v[224:225], v[224:225], v[4:5]
    v_mfma_f32_32x32x16_bf16 v[176:191], v[96:99], v[64:67], v[176:191]
    v_pk_add_f32 v[226:227], v[226:227], v[6:7]
    v_pk_add_f32 v[228:229], v[228:229], v[8:9]
    v_pk_add_f32 v[230:231], v[230:231], v[10:11]
    v_cvt_pk_bf16_f32 v44, v224, v225
    v_cvt_pk_bf16_f32 v45, v226, v227
    v_cvt_pk_bf16_f32 v46, v228, v229
    v_cvt_pk_bf16_f32 v47, v230, v231
    s_add_u32 s31, s30, 262144
    s_nop 0
    v_permlane32_swap_b32 v44, v46
    v_permlane32_swap_b32 v45, v47
    buffer_store_dwordx4 v[44:47], v1, s[12:15], s31 offen offset:512 sc1
    v_pk_mul_f32 v[4:5], v[168:169], s[50:51]
    v_pk_mul_f32 v[6:7], v[170:171], s[50:51]
    v_pk_mul_f32 v[8:9], v[172:173], s[50:51]
    v_pk_mul_f32 v[10:11], v[174:175], s[50:51]
    v_exp_f32_e64 v4, v4 clamp
    v_max_f32 v168, s52, v168
    v_exp_f32_e64 v5, v5 clamp
    v_max_f32 v169, s52, v169
    v_exp_f32_e64 v6, v6 clamp
    v_max_f32 v170, s52, v170
    v_exp_f32_e64 v7, v7 clamp
    v_max_f32 v171, s52, v171
    v_exp_f32_e64 v8, v8 clamp
    v_max_f32 v172, s52, v172
    v_exp_f32_e64 v9, v9 clamp
    v_mfma_f32_32x32x16_bf16 v[240:255], v[96:99], v[68:71], v[240:255]
    v_max_f32 v173, s52, v173
    v_exp_f32_e64 v10, v10 clamp
    v_max_f32 v174, s52, v174
    v_exp_f32_e64 v11, v11 clamp
    v_max_f32 v175, s52, v175
    v_pk_add_f32 v[168:169], v[168:169], v[4:5]
    v_pk_add_f32 v[170:171], v[170:171], v[6:7]
    v_pk_add_f32 v[172:173], v[172:173], v[8:9]
    v_pk_add_f32 v[174:175], v[174:175], v[10:11]
    v_cvt_pk_bf16_f32 v48, v168, v169
    v_cvt_pk_bf16_f32 v49, v170, v171
    v_cvt_pk_bf16_f32 v50, v172, v173
    v_cvt_pk_bf16_f32 v51, v174, v175
    s_add_u32 s31, s30, 327680
    s_nop 0
    v_permlane32_swap_b32 v48, v50
    v_permlane32_swap_b32 v49, v51
    buffer_store_dwordx4 v[48:51], v1, s[12:15], s31 offen offset:0 sc1
    v_pk_mul_f32 v[4:5], v[232:233], s[50:51]
    v_pk_mul_f32 v[6:7], v[234:235], s[50:51]
    v_pk_mul_f32 v[8:9], v[236:237], s[50:51]
    v_pk_mul_f32 v[10:11], v[238:239], s[50:51]
    v_exp_f32_e64 v4, v4 clamp
    v_max_f32 v232, s52, v232
    v_exp_f32_e64 v5, v5 clamp
    v_max_f32 v233, s52, v233
    v_exp_f32_e64 v6, v6 clamp
    v_mfma_f32_32x32x16_bf16 v[176:191], v[100:103], v[72:75], v[176:191]
    v_max_f32 v234, s52, v234
    v_exp_f32_e64 v7, v7 clamp
    v_max_f32 v235, s52, v235
    v_exp_f32_e64 v8, v8 clamp
    v_max_f32 v236, s52, v236
    v_exp_f32_e64 v9, v9 clamp
    v_max_f32 v237, s52, v237
    v_exp_f32_e64 v10, v10 clamp
    v_max_f32 v238, s52, v238
    v_exp_f32_e64 v11, v11 clamp
    v_max_f32 v239, s52, v239
    v_pk_add_f32 v[232:233], v[232:233], v[4:5]
    v_pk_add_f32 v[234:235], v[234:235], v[6:7]
    v_pk_add_f32 v[236:237], v[236:237], v[8:9]
    v_pk_add_f32 v[238:239], v[238:239], v[10:11]
    v_cvt_pk_bf16_f32 v52, v232, v233
    v_cvt_pk_bf16_f32 v53, v234, v235
    v_cvt_pk_bf16_f32 v54, v236, v237
    v_cvt_pk_bf16_f32 v55, v238, v239
    s_add_u32 s31, s30, 327680
    s_nop 0
    v_permlane32_swap_b32 v52, v54
    v_permlane32_swap_b32 v53, v55
    buffer_store_dwordx4 v[52:55], v1, s[12:15], s31 offen offset:512 sc1
    v_mfma_f32_32x32x16_bf16 v[240:255], v[100:103], v[76:79], v[240:255]
    s_nop 7
    s_nop 3
    v_pk_mul_f32 v[4:5], v[176:177], s[50:51]
    v_pk_mul_f32 v[6:7], v[178:179], s[50:51]
    v_pk_mul_f32 v[8:9], v[180:181], s[50:51]
    v_pk_mul_f32 v[10:11], v[182:183], s[50:51]
    v_exp_f32_e64 v4, v4 clamp
    v_max_f32 v176, s52, v176
    v_exp_f32_e64 v5, v5 clamp
    v_max_f32 v177, s52, v177
    v_exp_f32_e64 v6, v6 clamp
    v_max_f32 v178, s52, v178
    v_exp_f32_e64 v7, v7 clamp
    v_max_f32 v179, s52, v179
    v_exp_f32_e64 v8, v8 clamp
    v_max_f32 v180, s52, v180
    v_exp_f32_e64 v9, v9 clamp
    v_max_f32 v181, s52, v181
    v_exp_f32_e64 v10, v10 clamp
    v_max_f32 v182, s52, v182
    v_exp_f32_e64 v11, v11 clamp
    v_max_f32 v183, s52, v183
    v_pk_add_f32 v[176:177], v[176:177], v[4:5]
    v_pk_add_f32 v[178:179], v[178:179], v[6:7]
    v_pk_add_f32 v[180:181], v[180:181], v[8:9]
    v_pk_add_f32 v[182:183], v[182:183], v[10:11]
    v_cvt_pk_bf16_f32 v32, v176, v177
    v_cvt_pk_bf16_f32 v33, v178, v179
    v_cvt_pk_bf16_f32 v34, v180, v181
    v_cvt_pk_bf16_f32 v35, v182, v183
    s_add_u32 s31, s30, 393216
    s_nop 0
    v_permlane32_swap_b32 v32, v34
    v_permlane32_swap_b32 v33, v35
    buffer_store_dwordx4 v[32:35], v1, s[12:15], s31 offen offset:0 sc1
    v_pk_mul_f32 v[4:5], v[240:241], s[50:51]
    v_pk_mul_f32 v[6:7], v[242:243], s[50:51]
    v_pk_mul_f32 v[8:9], v[244:245], s[50:51]
    v_pk_mul_f32 v[10:11], v[246:247], s[50:51]
    v_exp_f32_e64 v4, v4 clamp
    v_max_f32 v240, s52, v240
    v_exp_f32_e64 v5, v5 clamp
    v_max_f32 v241, s52, v241
    v_exp_f32_e64 v6, v6 clamp
    v_max_f32 v242, s52, v242
    v_exp_f32_e64 v7, v7 clamp
    v_max_f32 v243, s52, v243
    v_exp_f32_e64 v8, v8 clamp
    v_max_f32 v244, s52, v244
    v_exp_f32_e64 v9, v9 clamp
    v_max_f32 v245, s52, v245
    v_exp_f32_e64 v10, v10 clamp
    v_max_f32 v246, s52, v246
    v_exp_f32_e64 v11, v11 clamp
    v_max_f32 v247, s52, v247
    v_pk_add_f32 v[240:241], v[240:241], v[4:5]
    v_pk_add_f32 v[242:243], v[242:243], v[6:7]
    v_pk_add_f32 v[244:245], v[244:245], v[8:9]
    v_pk_add_f32 v[246:247], v[246:247], v[10:11]
    v_cvt_pk_bf16_f32 v36, v240, v241
    v_cvt_pk_bf16_f32 v37, v242, v243
    v_cvt_pk_bf16_f32 v38, v244, v245
    v_cvt_pk_bf16_f32 v39, v246, v247
    s_add_u32 s31, s30, 393216
    s_nop 0
    v_permlane32_swap_b32 v36, v38
    v_permlane32_swap_b32 v37, v39
    buffer_store_dwordx4 v[36:39], v1, s[12:15], s31 offen offset:512 sc1
    v_pk_mul_f32 v[4:5], v[184:185], s[50:51]
    v_pk_mul_f32 v[6:7], v[186:187], s[50:51]
    v_pk_mul_f32 v[8:9], v[188:189], s[50:51]
    v_pk_mul_f32 v[10:11], v[190:191], s[50:51]
    v_exp_f32_e64 v4, v4 clamp
    v_max_f32 v184, s52, v184
    v_exp_f32_e64 v5, v5 clamp
    v_max_f32 v185, s52, v185
    v_exp_f32_e64 v6, v6 clamp
    v_max_f32 v186, s52, v186
    v_exp_f32_e64 v7, v7 clamp
    v_max_f32 v187, s52, v187
    v_exp_f32_e64 v8, v8 clamp
    v_max_f32 v188, s52, v188
    v_exp_f32_e64 v9, v9 clamp
    v_max_f32 v189, s52, v189
    v_exp_f32_e64 v10, v10 clamp
    v_max_f32 v190, s52, v190
    v_exp_f32_e64 v11, v11 clamp
    v_max_f32 v191, s52, v191
    v_pk_add_f32 v[184:185], v[184:185], v[4:5]
    v_pk_add_f32 v[186:187], v[186:187], v[6:7]
    v_pk_add_f32 v[188:189], v[188:189], v[8:9]
    v_pk_add_f32 v[190:191], v[190:191], v[10:11]
    v_cvt_pk_bf16_f32 v40, v184, v185
    v_cvt_pk_bf16_f32 v41, v186, v187
    v_cvt_pk_bf16_f32 v42, v188, v189
    v_cvt_pk_bf16_f32 v43, v190, v191
    s_add_u32 s31, s30, 458752
    s_nop 0
    v_permlane32_swap_b32 v40, v42
    v_permlane32_swap_b32 v41, v43
    buffer_store_dwordx4 v[40:43], v1, s[12:15], s31 offen offset:0 sc1
    v_pk_mul_f32 v[4:5], v[248:249], s[50:51]
    v_pk_mul_f32 v[6:7], v[250:251], s[50:51]
    v_pk_mul_f32 v[8:9], v[252:253], s[50:51]
    v_pk_mul_f32 v[10:11], v[254:255], s[50:51]
    v_exp_f32_e64 v4, v4 clamp
    v_max_f32 v248, s52, v248
    v_exp_f32_e64 v5, v5 clamp
    v_max_f32 v249, s52, v249
    v_exp_f32_e64 v6, v6 clamp
    v_max_f32 v250, s52, v250
    v_exp_f32_e64 v7, v7 clamp
    v_max_f32 v251, s52, v251
    v_exp_f32_e64 v8, v8 clamp
    v_max_f32 v252, s52, v252
    v_exp_f32_e64 v9, v9 clamp
    v_max_f32 v253, s52, v253
    v_exp_f32_e64 v10, v10 clamp
    v_max_f32 v254, s52, v254
    v_exp_f32_e64 v11, v11 clamp
    v_max_f32 v255, s52, v255
    v_pk_add_f32 v[248:249], v[248:249], v[4:5]
    v_pk_add_f32 v[250:251], v[250:251], v[6:7]
    v_pk_add_f32 v[252:253], v[252:253], v[8:9]
    v_pk_add_f32 v[254:255], v[254:255], v[10:11]
    v_cvt_pk_bf16_f32 v44, v248, v249
    v_cvt_pk_bf16_f32 v45, v250, v251
    v_cvt_pk_bf16_f32 v46, v252, v253
    v_cvt_pk_bf16_f32 v47, v254, v255
    s_add_u32 s31, s30, 458752
    s_nop 0
    v_permlane32_swap_b32 v44, v46
    v_permlane32_swap_b32 v45, v47
    buffer_store_dwordx4 v[44:47], v1, s[12:15], s31 offen offset:512 sc1
    s_branch p2_C
k1_F:
    s_cmp_eq_u32 s46, 2
    s_cbranch_scc1 k1_KVsetup
    s_mov_b32 s56, 81920
    v_and_b32 v1, 31, v0
    v_bfe_u32 v2, v0, 5, 1
    v_add_u32 v1, s27, v1
    v_mul_u32_u24 v2, 320, v2
    s_lshl_b32 s30, s22, 4
    s_lshl_b32 s31, s16, 2
    s_add_u32 s30, s30, s31
    s_mul_i32 s30, s30, 640
    s_add_u32 s30, s30, s28
    v_add_u32 v2, s30, v2
    v_add_u32 v3, 0, v1
    v_mul_u32_u24 v4, 3277, v3
    v_lshrrev_b32 v4, 16, v4
    v_mul_u32_u24 v7, 20, v4
    v_sub_u32 v3, v3, v7
    v_and_b32 v7, 1, v4
    v_lshlrev_b32 v7, 2, v7
    v_sub_u32 v3, v3, v7
    v_add_u32 v7, 20, v3
    v_min_u32 v3, v3, v7
    v_lshl_add_u32 v3, v3, 4, v2
    v_mad_u32_u24 v8, v4, s56, v3
    v_add_u32 v3, 32, v1
    v_mul_u32_u24 v4, 3277, v3
    v_lshrrev_b32 v4, 16, v4
    v_mul_u32_u24 v7, 20, v4
    v_sub_u32 v3, v3, v7
    v_and_b32 v7, 1, v4
    v_lshlrev_b32 v7, 2, v7
    v_sub_u32 v3, v3, v7
    v_add_u32 v7, 20, v3
    v_min_u32 v3, v3, v7
    v_lshl_add_u32 v3, v3, 4, v2
    v_mad_u32_u24 v9, v4, s56, v3
    v_add_u32 v3, 64, v1
    v_mul_u32_u24 v4, 3277, v3
    v_lshrrev_b32 v4, 16, v4
    v_mul_u32_u24 v7, 20, v4
    v_sub_u32 v3, v3, v7
    v_and_b32 v7, 1, v4
    v_lshlrev_b32 v7, 2, v7
    v_sub_u32 v3, v3, v7
    v_add_u32 v7, 20, v3
    v_min_u32 v3, v3, v7
    v_lshl_add_u32 v3, v3, 4, v2
    v_mad_u32_u24 v10, v4, s56, v3
    v_add_u32 v3, 96, v1
    v_mul_u32_u24 v4, 3277, v3
    v_lshrrev_b32 v4, 16, v4
    v_mul_u32_u24 v7, 20, v4
    v_sub_u32 v3, v3, v7
    v_and_b32 v7, 1, v4
    v_lshlrev_b32 v7, 2, v7
    v_sub_u32 v3, v3, v7
    v_add_u32 v7, 20, v3
    v_min_u32 v3, v3, v7
    v_lshl_add_u32 v3, v3, 4, v2
    v_mad_u32_u24 v11, v4, s56, v3
    v_bfrev_b32 v112, 1
    v_bfrev_b32 v113, 1
    v_bfrev_b32 v114, 1
    v_bfrev_b32 v115, 1
    v_bfrev_b32 v116, 1
    v_bfrev_b32 v117, 1
    v_bfrev_b32 v118, 1
    v_bfrev_b32 v119, 1
    v_bfrev_b32 v120, 1
    v_bfrev_b32 v121, 1
    v_bfrev_b32 v122, 1
    v_bfrev_b32 v123, 1
    v_bfrev_b32 v124, 1
    v_bfrev_b32 v125, 1
    v_bfrev_b32 v126, 1
    v_bfrev_b32 v127, 1
    s_branch k1_Fmain
k1_KVsetup:
    s_and_b32 s29, s23, 1
    s_lshl_b32 s38, s29, 2
    s_mul_i32 s31, s23, 3
    s_cmp_lg_u32 s29, 0
    s_cselect_b32 s39, -4, 60
    s_lshl_b32 s30, s22, 2
    s_add_u32 s30, s30, s16
    s_lshl_b32 s30, s30, 5
    s_add_u32 s30, s30, s31
    s_mul_i32 s30, s30, 1680
    s_add_u32 s30, s30, 11010048
    s_sub_u32 s34, 32, s31
    s_min_u32 s34, s34, 3
    s_mov_b32 s35, 1680
    v_bfe_u32 v4, v0, 5, 1
    v_subrev_u32 v4, s29, v4
    v_bfrev_b32 v14, 1
    v_and_b32 v1, 31, v0
    v_add_u32 v1, 0, v1
    v_subrev_u32 v1, s38, v1
    v_cmp_eq_u32 s[60:61], s39, v1
    v_and_b32 v1, 0xff, v1
    v_mul_u32_u24 v2, 3277, v1
    v_lshrrev_b32 v8, 16, v2
    v_mul_u32_u24 v3, 20, v8
    v_sub_u32 v3, v1, v3
    v_add_u32 v5, s31, v8
    v_and_b32 v5, 1, v5
    v_lshlrev_b32 v5, 2, v5
    v_sub_u32 v3, v3, v5
    v_add_u32 v5, 20, v3
    v_min_u32 v3, v3, v5
    v_cndmask_b32 v3, v3, 20, s[60:61]
    v_lshlrev_b32 v3, 4, v3
    v_add_u32 v10, s30, v3
    v_and_b32 v1, 31, v0
    v_add_u32 v1, 32, v1
    v_subrev_u32 v1, s38, v1
    v_cmp_eq_u32 s[62:63], s39, v1
    v_and_b32 v1, 0xff, v1
    v_mul_u32_u24 v2, 3277, v1
    v_lshrrev_b32 v9, 16, v2
    v_mul_u32_u24 v3, 20, v9
    v_sub_u32 v3, v1, v3
    v_add_u32 v5, s31, v9
    v_and_b32 v5, 1, v5
    v_lshlrev_b32 v5, 2, v5
    v_sub_u32 v3, v3, v5
    v_add_u32 v5, 20, v3
    v_min_u32 v3, v3, v5
    v_cndmask_b32 v3, v3, 20, s[62:63]
    v_lshlrev_b32 v3, 4, v3
    v_add_u32 v11, s30, v3
    v_add_u32 v5, 0, v4
    v_and_b32 v5, 0xff, v5
    v_mul_u32_u24 v6, 205, v5
    v_lshrrev_b32 v6, 10, v6
    v_cmp_gt_u32 s[36:37], s34, v6
    v_cmp_eq_u32 s[64:65], v6, v8
    v_cmp_eq_u32 s[66:67], v6, v9
    v_mul_u32_u24 v7, 5, v6
    v_sub_u32 v5, v5, v7
    v_add_u32 v7, s31, v6
    v_and_b32 v7, 1, v7
    v_sub_u32 v5, v5, v7
    v_add_u32 v7, 5, v5
    v_min_u32 v5, v5, v7
    v_mul_u32_u24 v5, 336, v5
    v_mad_u32_u24 v5, v6, s35, v5
    s_or_b64 s[64:65], s[64:65], s[60:61]
    s_or_b64 s[66:67], s[66:67], s[62:63]
    s_and_b64 s[64:65], s[64:65], s[36:37]
    s_and_b64 s[66:67], s[66:67], s[36:37]
    v_add_u32 v6, v5, v10
    v_add_u32 v7, v5, v11
    v_cndmask_b32 v112, v14, v6, s[64:65]
    v_cndmask_b32 v116, v14, v7, s[66:67]
    v_add_u32 v5, 2, v4
    v_and_b32 v5, 0xff, v5
    v_mul_u32_u24 v6, 205, v5
    v_lshrrev_b32 v6, 10, v6
    v_cmp_gt_u32 s[36:37], s34, v6
    v_cmp_eq_u32 s[64:65], v6, v8
    v_cmp_eq_u32 s[66:67], v6, v9
    v_mul_u32_u24 v7, 5, v6
    v_sub_u32 v5, v5, v7
    v_add_u32 v7, s31, v6
    v_and_b32 v7, 1, v7
    v_sub_u32 v5, v5, v7
    v_add_u32 v7, 5, v5
    v_min_u32 v5, v5, v7
    v_mul_u32_u24 v5, 336, v5
    v_mad_u32_u24 v5, v6, s35, v5
    s_or_b64 s[64:65], s[64:65], s[60:61]
    s_or_b64 s[66:67], s[66:67], s[62:63]
    s_and_b64 s[64:65], s[64:65], s[36:37]
    s_and_b64 s[66:67], s[66:67], s[36:37]
    v_add_u32 v6, v5, v10
    v_add_u32 v7, v5, v11
    v_cndmask_b32 v113, v14, v6, s[64:65]
    v_cndmask_b32 v117, v14, v7, s[66:67]
    v_add_u32 v5, 4, v4
    v_and_b32 v5, 0xff, v5
    v_mul_u32_u24 v6, 205, v5
    v_lshrrev_b32 v6, 10, v6
    v_cmp_gt_u32 s[36:37], s34, v6
    v_cmp_eq_u32 s[64:65], v6, v8
    v_cmp_eq_u32 s[66:67], v6, v9
    v_mul_u32_u24 v7, 5, v6
    v_sub_u32 v5, v5, v7
    v_add_u32 v7, s31, v6
    v_and_b32 v7, 1, v7
    v_sub_u32 v5, v5, v7
    v_add_u32 v7, 5, v5
    v_min_u32 v5, v5, v7
    v_mul_u32_u24 v5, 336, v5
    v_mad_u32_u24 v5, v6, s35, v5
    s_or_b64 s[64:65], s[64:65], s[60:61]
    s_or_b64 s[66:67], s[66:67], s[62:63]
    s_and_b64 s[64:65], s[64:65], s[36:37]
    s_and_b64 s[66:67], s[66:67], s[36:37]
    v_add_u32 v6, v5, v10
    v_add_u32 v7, v5, v11
    v_cndmask_b32 v114, v14, v6, s[64:65]
    v_cndmask_b32 v118, v14, v7, s[66:67]
    v_add_u32 v5, 6, v4
    v_and_b32 v5, 0xff, v5
    v_mul_u32_u24 v6, 205, v5
    v_lshrrev_b32 v6, 10, v6
    v_cmp_gt_u32 s[36:37], s34, v6
    v_cmp_eq_u32 s[64:65], v6, v8
    v_cmp_eq_u32 s[66:67], v6, v9
    v_mul_u32_u24 v7, 5, v6
    v_sub_u32 v5, v5, v7
    v_add_u32 v7, s31, v6
    v_and_b32 v7, 1, v7
    v_sub_u32 v5, v5, v7
    v_add_u32 v7, 5, v5
    v_min_u32 v5, v5, v7
    v_mul_u32_u24 v5, 336, v5
    v_mad_u32_u24 v5, v6, s35, v5
    s_or_b64 s[64:65], s[64:65], s[60:61]
    s_or_b64 s[66:67], s[66:67], s[62:63]
    s_and_b64 s[64:65], s[64:65], s[36:37]
    s_and_b64 s[66:67], s[66:67], s[36:37]
    v_add_u32 v6, v5, v10
    v_add_u32 v7, v5, v11
    v_cndmask_b32 v115, v14, v6, s[64:65]
    v_cndmask_b32 v119, v14, v7, s[66:67]
    v_add_u32 v5, 8, v4
    v_and_b32 v5, 0xff, v5
    v_mul_u32_u24 v6, 205, v5
    v_lshrrev_b32 v6, 10, v6
    v_cmp_gt_u32 s[36:37], s34, v6
    v_cmp_eq_u32 s[64:65], v6, v8
    v_cmp_eq_u32 s[66:67], v6, v9
    v_mul_u32_u24 v7, 5, v6
    v_sub_u32 v5, v5, v7
    v_add_u32 v7, s31, v6
    v_and_b32 v7, 1, v7
    v_sub_u32 v5, v5, v7
    v_add_u32 v7, 5, v5
    v_min_u32 v5, v5, v7
    v_mul_u32_u24 v5, 336, v5
    v_mad_u32_u24 v5, v6, s35, v5
    s_or_b64 s[64:65], s[64:65], s[60:61]
    s_or_b64 s[66:67], s[66:67], s[62:63]
    s_and_b64 s[64:65], s[64:65], s[36:37]
    s_and_b64 s[66:67], s[66:67], s[36:37]
    v_add_u32 v6, v5, v10
    v_add_u32 v7, v5, v11
    v_cndmask_b32 v120, v14, v6, s[64:65]
    v_cndmask_b32 v124, v14, v7, s[66:67]
    v_add_u32 v5, 10, v4
    v_and_b32 v5, 0xff, v5
    v_mul_u32_u24 v6, 205, v5
    v_lshrrev_b32 v6, 10, v6
    v_cmp_gt_u32 s[36:37], s34, v6
    v_cmp_eq_u32 s[64:65], v6, v8
    v_cmp_eq_u32 s[66:67], v6, v9
    v_mul_u32_u24 v7, 5, v6
    v_sub_u32 v5, v5, v7
    v_add_u32 v7, s31, v6
    v_and_b32 v7, 1, v7
    v_sub_u32 v5, v5, v7
    v_add_u32 v7, 5, v5
    v_min_u32 v5, v5, v7
    v_mul_u32_u24 v5, 336, v5
    v_mad_u32_u24 v5, v6, s35, v5
    s_or_b64 s[64:65], s[64:65], s[60:61]
    s_or_b64 s[66:67], s[66:67], s[62:63]
    s_and_b64 s[64:65], s[64:65], s[36:37]
    s_and_b64 s[66:67], s[66:67], s[36:37]
    v_add_u32 v6, v5, v10
    v_add_u32 v7, v5, v11
    v_cndmask_b32 v121, v14, v6, s[64:65]
    v_cndmask_b32 v125, v14, v7, s[66:67]
    v_add_u32 v5, 12, v4
    v_and_b32 v5, 0xff, v5
    v_mul_u32_u24 v6, 205, v5
    v_lshrrev_b32 v6, 10, v6
    v_cmp_gt_u32 s[36:37], s34, v6
    v_cmp_eq_u32 s[64:65], v6, v8
    v_cmp_eq_u32 s[66:67], v6, v9
    v_mul_u32_u24 v7, 5, v6
    v_sub_u32 v5, v5, v7
    v_add_u32 v7, s31, v6
    v_and_b32 v7, 1, v7
    v_sub_u32 v5, v5, v7
    v_add_u32 v7, 5, v5
    v_min_u32 v5, v5, v7
    v_mul_u32_u24 v5, 336, v5
    v_mad_u32_u24 v5, v6, s35, v5
    s_or_b64 s[64:65], s[64:65], s[60:61]
    s_or_b64 s[66:67], s[66:67], s[62:63]
    s_and_b64 s[64:65], s[64:65], s[36:37]
    s_and_b64 s[66:67], s[66:67], s[36:37]
    v_add_u32 v6, v5, v10
    v_add_u32 v7, v5, v11
    v_cndmask_b32 v122, v14, v6, s[64:65]
    v_cndmask_b32 v126, v14, v7, s[66:67]
    v_add_u32 v5, 14, v4
    v_and_b32 v5, 0xff, v5
    v_mul_u32_u24 v6, 205, v5
    v_lshrrev_b32 v6, 10, v6
    v_cmp_gt_u32 s[36:37], s34, v6
    v_cmp_eq_u32 s[64:65], v6, v8
    v_cmp_eq_u32 s[66:67], v6, v9
    v_mul_u32_u24 v7, 5, v6
    v_sub_u32 v5, v5, v7
    v_add_u32 v7, s31, v6
    v_and_b32 v7, 1, v7
    v_sub_u32 v5, v5, v7
    v_add_u32 v7, 5, v5
    v_min_u32 v5, v5, v7
    v_mul_u32_u24 v5, 336, v5
    v_mad_u32_u24 v5, v6, s35, v5
    s_or_b64 s[64:65], s[64:65], s[60:61]
    s_or_b64 s[66:67], s[66:67], s[62:63]
    s_and_b64 s[64:65], s[64:65], s[36:37]
    s_and_b64 s[66:67], s[66:67], s[36:37]
    v_add_u32 v6, v5, v10
    v_add_u32 v7, v5, v11
    v_cndmask_b32 v123, v14, v6, s[64:65]
    v_cndmask_b32 v127, v14, v7, s[66:67]
k1_Fmain:
    v_pk_mov_b32 v[128:129], 0, 0
    v_pk_mov_b32 v[130:131], 0, 0
    v_pk_mov_b32 v[132:133], 0, 0
    v_pk_mov_b32 v[134:135], 0, 0
    v_pk_mov_b32 v[136:137], 0, 0
    v_pk_mov_b32 v[138:139], 0, 0
    v_pk_mov_b32 v[140:141], 0, 0
    v_pk_mov_b32 v[142:143], 0, 0
    v_pk_mov_b32 v[144:145], 0, 0
    v_pk_mov_b32 v[146:147], 0, 0
    v_pk_mov_b32 v[148:149], 0, 0
    v_pk_mov_b32 v[150:151], 0, 0
    v_pk_mov_b32 v[152:153], 0, 0
    v_pk_mov_b32 v[154:155], 0, 0
    v_pk_mov_b32 v[156:157], 0, 0
    v_pk_mov_b32 v[158:159], 0, 0
    v_pk_mov_b32 v[160:161], 0, 0
    v_pk_mov_b32 v[162:163], 0, 0
    v_pk_mov_b32 v[164:165], 0, 0
    v_pk_mov_b32 v[166:167], 0, 0
    v_pk_mov_b32 v[168:169], 0, 0
    v_pk_mov_b32 v[170:171], 0, 0
    v_pk_mov_b32 v[172:173], 0, 0
    v_pk_mov_b32 v[174:175], 0, 0
    v_pk_mov_b32 v[176:177], 0, 0
    v_pk_mov_b32 v[178:179], 0, 0
    v_pk_mov_b32 v[180:181], 0, 0
    v_pk_mov_b32 v[182:183], 0, 0
    v_pk_mov_b32 v[184:185], 0, 0
    v_pk_mov_b32 v[186:187], 0, 0
    v_pk_mov_b32 v[188:189], 0, 0
    v_pk_mov_b32 v[190:191], 0, 0
    v_pk_mov_b32 v[192:193], 0, 0
    v_pk_mov_b32 v[194:195], 0, 0
    v_pk_mov_b32 v[196:197], 0, 0
    v_pk_mov_b32 v[198:199], 0, 0
    v_pk_mov_b32 v[200:201], 0, 0
    v_pk_mov_b32 v[202:203], 0, 0
    v_pk_mov_b32 v[204:205], 0, 0
    v_pk_mov_b32 v[206:207], 0, 0
    v_pk_mov_b32 v[208:209], 0, 0
    v_pk_mov_b32 v[210:211], 0, 0
    v_pk_mov_b32 v[212:213], 0, 0
    v_pk_mov_b32 v[214:215], 0, 0
    v_pk_mov_b32 v[216:217], 0, 0
    v_pk_mov_b32 v[218:219], 0, 0
    v_pk_mov_b32 v[220:221], 0, 0
    v_pk_mov_b32 v[222:223], 0, 0
    v_pk_mov_b32 v[224:225], 0, 0
    v_pk_mov_b32 v[226:227], 0, 0
    v_pk_mov_b32 v[228:229], 0, 0
    v_pk_mov_b32 v[230:231], 0, 0
    v_pk_mov_b32 v[232:233], 0, 0
    v_pk_mov_b32 v[234:235], 0, 0
    v_pk_mov_b32 v[236:237], 0, 0
    v_pk_mov_b32 v[238:239], 0, 0
    v_pk_mov_b32 v[240:241], 0, 0
    v_pk_mov_b32 v[242:243], 0, 0
    v_pk_mov_b32 v[244:245], 0, 0
    v_pk_mov_b32 v[246:247], 0, 0
    v_pk_mov_b32 v[248:249], 0, 0
    v_pk_mov_b32 v[250:251], 0, 0
    v_pk_mov_b32 v[252:253], 0, 0
    v_pk_mov_b32 v[254:255], 0, 0
    s_mov_b32 s43, 0
    s_mov_b32 s44, 0
    s_mov_b32 s48, 49152
    s_barrier
    ds_read_b128 v[32:35], v16 offset:0
    ds_read_b128 v[36:39], v16 offset:4096
    ds_read_b64_tr_b16 v[40:41], v20 offset:0
    ds_read_b64_tr_b16 v[42:43], v20 offset:1024
    ds_read_b64_tr_b16 v[44:45], v21 offset:0
    ds_read_b64_tr_b16 v[46:47], v21 offset:1024
    ds_read_b64_tr_b16 v[48:49], v22 offset:0
    ds_read_b64_tr_b16 v[50:51], v22 offset:1024
    ds_read_b64_tr_b16 v[52:53], v23 offset:0
    ds_read_b64_tr_b16 v[54:55], v23 offset:1024
    .p2align 6
k1F_loop:
    s_waitcnt lgkmcnt(0)
    v_mfma_f32_32x32x16_bf16 v[128:143], v[32:35], v[40:43], v[128:143]
    ds_read_b128 v[56:59], v17 offset:0
    ds_read_b128 v[60:63], v17 offset:4096
    ds_read_b64_tr_b16 v[64:65], v20 offset:4096
    v_mfma_f32_32x32x16_bf16 v[192:207], v[36:39], v[40:43], v[192:207]
    ds_read_b64_tr_b16 v[66:67], v20 offset:5120
    ds_read_b64_tr_b16 v[68:69], v21 offset:4096
    ds_read_b64_tr_b16 v[70:71], v21 offset:5120
    v_mfma_f32_32x32x16_bf16 v[144:159], v[32:35], v[44:47], v[144:159]
    ds_read_b64_tr_b16 v[72:73], v22 offset:4096
    ds_read_b64_tr_b16 v[74:75], v22 offset:5120
    ds_read_b64_tr_b16 v[76:77], v23 offset:4096
    v_mfma_f32_32x32x16_bf16 v[208:223], v[36:39], v[44:47], v[208:223]
    ds_read_b64_tr_b16 v[78:79], v23 offset:5120
    v_mfma_f32_32x32x16_bf16 v[160:175], v[32:35], v[48:51], v[160:175]
    v_mfma_f32_32x32x16_bf16 v[224:239], v[36:39], v[48:51], v[224:239]
    v_mfma_f32_32x32x16_bf16 v[176:191], v[32:35], v[52:55], v[176:191]
    v_mfma_f32_32x32x16_bf16 v[240:255], v[36:39], v[52:55], v[240:255]
    s_waitcnt lgkmcnt(0)
    v_mfma_f32_32x32x16_bf16 v[128:143], v[56:59], v[64:67], v[128:143]
    ds_read_b128 v[32:35], v18 offset:0
    ds_read_b128 v[36:39], v18 offset:4096
    ds_read_b64_tr_b16 v[40:41], v20 offset:8192
    v_mfma_f32_32x32x16_bf16 v[192:207], v[60:63], v[64:67], v[192:207]
    ds_read_b64_tr_b16 v[42:43], v20 offset:9216
    ds_read_b64_tr_b16 v[44:45], v21 offset:8192
    ds_read_b64_tr_b16 v[46:47], v21 offset:9216
    v_mfma_f32_32x32x16_bf16 v[144:159], v[56:59], v[68:71], v[144:159]
    ds_read_b64_tr_b16 v[48:49], v22 offset:8192
    ds_read_b64_tr_b16 v[50:51], v22 offset:9216
    ds_read_b64_tr_b16 v[52:53], v23 offset:8192
    v_mfma_f32_32x32x16_bf16 v[208:223], v[60:63], v[68:71], v[208:223]
    ds_read_b64_tr_b16 v[54:55], v23 offset:9216
    v_mfma_f32_32x32x16_bf16 v[160:175], v[56:59], v[72:75], v[160:175]
    v_mfma_f32_32x32x16_bf16 v[224:239], v[60:63], v[72:75], v[224:239]
    s_and_b32 s58, s18, 7
    s_lshl_b32 s58, s58, 4
    s_or_b32 s58, s58, s43
    v_mfma_f32_32x32x16_bf16 v[176:191], v[56:59], v[76:79], v[176:191]
    s_cmp_lg_u32 s58, 1
    s_cbranch_scc1 k1F_noic
    global_load_dword v30, v[28:29], off
k1F_noic:
    v_mfma_f32_32x32x16_bf16 v[240:255], v[60:63], v[76:79], v[240:255]
    s_waitcnt lgkmcnt(0)
    v_mfma_f32_32x32x16_bf16 v[128:143], v[32:35], v[40:43], v[128:143]
    ds_read_b128 v[56:59], v19 offset:0
    ds_read_b128 v[60:63], v19 offset:4096
    ds_read_b64_tr_b16 v[64:65], v20 offset:12288
    v_mfma_f32_32x32x16_bf16 v[192:207], v[36:39], v[40:43], v[192:207]
    ds_read_b64_tr_b16 v[66:67], v20 offset:13312
    ds_read_b64_tr_b16 v[68:69], v21 offset:12288
    ds_read_b64_tr_b16 v[70:71], v21 offset:13312
    v_mfma_f32_32x32x16_bf16 v[144:159], v[32:35], v[44:47], v[144:159]
    ds_read_b64_tr_b16 v[72:73], v22 offset:12288
    ds_read_b64_tr_b16 v[74:75], v22 offset:13312
    ds_read_b64_tr_b16 v[76:77], v23 offset:12288
    v_mfma_f32_32x32x16_bf16 v[208:223], v[36:39], v[44:47], v[208:223]
    ds_read_b64_tr_b16 v[78:79], v23 offset:13312
    v_mfma_f32_32x32x16_bf16 v[160:175], v[32:35], v[48:51], v[160:175]
    v_mfma_f32_32x32x16_bf16 v[224:239], v[36:39], v[48:51], v[224:239]
    v_mfma_f32_32x32x16_bf16 v[176:191], v[32:35], v[52:55], v[176:191]
    v_mfma_f32_32x32x16_bf16 v[240:255], v[36:39], v[52:55], v[240:255]
    s_add_u32 s44, s44, 1
    s_cmp_eq_u32 s44, 3
    s_cselect_b32 s45, 4294868992, s48
    s_cselect_b32 s44, 0, s44
    s_add_u32 s43, s43, 1
    s_waitcnt lgkmcnt(0)
    v_mfma_f32_32x32x16_bf16 v[128:143], v[56:59], v[64:67], v[128:143]
    s_barrier
    v_mfma_f32_32x32x16_bf16 v[192:207], v[60:63], v[64:67], v[192:207]
    v_add_u32 v16, s45, v16
    v_add_u32 v20, s45, v20
    v_add_u32 v21, s45, v21
    v_add_u32 v22, s45, v22
    v_add_u32 v23, s45, v23
    v_mfma_f32_32x32x16_bf16 v[144:159], v[56:59], v[68:71], v[144:159]
    ds_read_b128 v[32:35], v16 offset:0
    ds_read_b128 v[36:39], v16 offset:4096
    ds_read_b64_tr_b16 v[40:41], v20 offset:0
    v_mfma_f32_32x32x16_bf16 v[208:223], v[60:63], v[68:71], v[208:223]
    ds_read_b64_tr_b16 v[42:43], v20 offset:1024
    ds_read_b64_tr_b16 v[44:45], v21 offset:0
    ds_read_b64_tr_b16 v[46:47], v21 offset:1024
    v_mfma_f32_32x32x16_bf16 v[160:175], v[56:59], v[72:75], v[160:175]
    ds_read_b64_tr_b16 v[48:49], v22 offset:0
    ds_read_b64_tr_b16 v[50:51], v22 offset:1024
    ds_read_b64_tr_b16 v[52:53], v23 offset:0
    v_mfma_f32_32x32x16_bf16 v[224:239], v[60:63], v[72:75], v[224:239]
    ds_read_b64_tr_b16 v[54:55], v23 offset:1024
    v_add_u32 v17, s45, v17
    v_add_u32 v18, s45, v18
    v_add_u32 v19, s45, v19
    v_mfma_f32_32x32x16_bf16 v[176:191], v[56:59], v[76:79], v[176:191]
    s_cmp_lt_u32 s43, 9
    v_mfma_f32_32x32x16_bf16 v[240:255], v[60:63], v[76:79], v[240:255]
    s_cbranch_scc1 k1F_loop
    s_cmp_eq_u32 s46, 2
    s_cbranch_scc1 k1_KV
    s_waitcnt vmcnt(0) lgkmcnt(0)
    v_mfma_f32_32x32x16_bf16 v[128:143], v[32:35], v[40:43], v[128:143]
    ds_read_b128 v[56:59], v17 offset:0
    ds_read_b128 v[60:63], v17 offset:4096
    ds_read_b64_tr_b16 v[80:81], v20 offset:4096
    v_mfma_f32_32x32x16_bf16 v[192:207], v[36:39], v[40:43], v[192:207]
    ds_read_b64_tr_b16 v[82:83], v20 offset:5120
    ds_read_b128 v[64:67], v18 offset:0
    ds_read_b128 v[68:71], v18 offset:4096
    v_mfma_f32_32x32x16_bf16 v[144:159], v[32:35], v[44:47], v[144:159]
    ds_read_b64_tr_b16 v[84:85], v20 offset:8192
    ds_read_b64_tr_b16 v[86:87], v20 offset:9216
    ds_read_b128 v[72:75], v19 offset:0
    v_mfma_f32_32x32x16_bf16 v[208:223], v[36:39], v[44:47], v[208:223]
    ds_read_b128 v[76:79], v19 offset:4096
    ds_read_b64_tr_b16 v[88:89], v20 offset:12288
    ds_read_b64_tr_b16 v[90:91], v20 offset:13312
    v_mfma_f32_32x32x16_bf16 v[160:175], v[32:35], v[48:51], v[160:175]
    ds_read_b64_tr_b16 v[92:93], v21 offset:4096
    ds_read_b64_tr_b16 v[94:95], v21 offset:5120
    ds_read_b64_tr_b16 v[96:97], v21 offset:8192
    v_mfma_f32_32x32x16_bf16 v[224:239], v[36:39], v[48:51], v[224:239]
    ds_read_b64_tr_b16 v[98:99], v21 offset:9216
    ds_read_b64_tr_b16 v[100:101], v21 offset:12288
    ds_read_b64_tr_b16 v[102:103], v21 offset:13312
    v_mfma_f32_32x32x16_bf16 v[176:191], v[32:35], v[52:55], v[176:191]
    v_mfma_f32_32x32x16_bf16 v[240:255], v[36:39], v[52:55], v[240:255]
    s_waitcnt lgkmcnt(6)
    v_mfma_f32_32x32x16_bf16 v[128:143], v[56:59], v[80:83], v[128:143]
    v_mfma_f32_32x32x16_bf16 v[192:207], v[60:63], v[80:83], v[192:207]
    v_mfma_f32_32x32x16_bf16 v[128:143], v[64:67], v[84:87], v[128:143]
    v_mfma_f32_32x32x16_bf16 v[192:207], v[68:71], v[84:87], v[192:207]
    v_mfma_f32_32x32x16_bf16 v[128:143], v[72:75], v[88:91], v[128:143]
    v_mfma_f32_32x32x16_bf16 v[192:207], v[76:79], v[88:91], v[192:207]
    s_waitcnt lgkmcnt(0)
    v_mfma_f32_32x32x16_bf16 v[144:159], v[56:59], v[92:95], v[144:159]
    ds_read_b64_tr_b16 v[80:81], v22 offset:4096
    ds_read_b64_tr_b16 v[82:83], v22 offset:5120
    ds_read_b64_tr_b16 v[84:85], v22 offset:8192
    ds_read_b64_tr_b16 v[86:87], v22 offset:9216
    ds_read_b64_tr_b16 v[88:89], v22 offset:12288
    ds_read_b64_tr_b16 v[90:91], v22 offset:13312
    s_nop 4
    v_cvt_pk_bf16_f32 v32, v128, v129
    v_cvt_pk_bf16_f32 v33, v130, v131
    v_cvt_pk_bf16_f32 v34, v132, v133
    v_cvt_pk_bf16_f32 v35, v134, v135
    v_mfma_f32_32x32x16_bf16 v[208:223], v[60:63], v[92:95], v[208:223]
    buffer_store_dwordx4 v[32:35], v8, s[12:15], 0 offen offset:0 sc1
    v_cvt_pk_bf16_f32 v36, v136, v137
    v_cvt_pk_bf16_f32 v37, v138, v139
    v_cvt_pk_bf16_f32 v38, v140, v141
    v_mfma_f32_32x32x16_bf16 v[144:159], v[64:67], v[96:99], v[144:159]
    v_cvt_pk_bf16_f32 v39, v142, v143
    buffer_store_dwordx4 v[36:39], v8, s[12:15], 0 offen offset:640 sc1
    v_cvt_pk_bf16_f32 v40, v192, v193
    v_cvt_pk_bf16_f32 v41, v194, v195
    v_mfma_f32_32x32x16_bf16 v[208:223], v[68:71], v[96:99], v[208:223]
    v_cvt_pk_bf16_f32 v42, v196, v197
    v_cvt_pk_bf16_f32 v43, v198, v199
    buffer_store_dwordx4 v[40:43], v8, s[12:15], 0 offen offset:1280 sc1
    v_cvt_pk_bf16_f32 v44, v200, v201
    v_mfma_f32_32x32x16_bf16 v[144:159], v[72:75], v[100:103], v[144:159]
    v_cvt_pk_bf16_f32 v45, v202, v203
    v_cvt_pk_bf16_f32 v46, v204, v205
    v_cvt_pk_bf16_f32 v47, v206, v207
    buffer_store_dwordx4 v[44:47], v8, s[12:15], 0 offen offset:1920 sc1
    v_mfma_f32_32x32x16_bf16 v[208:223], v[76:79], v[100:103], v[208:223]
    s_waitcnt lgkmcnt(0)
    v_mfma_f32_32x32x16_bf16 v[160:175], v[56:59], v[80:83], v[160:175]
    ds_read_b64_tr_b16 v[92:93], v23 offset:4096
    ds_read_b64_tr_b16 v[94:95], v23 offset:5120
    ds_read_b64_tr_b16 v[96:97], v23 offset:8192
    ds_read_b64_tr_b16 v[98:99], v23 offset:9216
    ds_read_b64_tr_b16 v[100:101], v23 offset:12288
    ds_read_b64_tr_b16 v[102:103], v23 offset:13312
    s_nop 4
    v_cvt_pk_bf16_f32 v48, v144, v145
    v_cvt_pk_bf16_f32 v49, v146, v147
    v_cvt_pk_bf16_f32 v50, v148, v149
    v_cvt_pk_bf16_f32 v51, v150, v151
    v_mfma_f32_32x32x16_bf16 v[224:239], v[60:63], v[80:83], v[224:239]
    buffer_store_dwordx4 v[48:51], v9, s[12:15], 0 offen offset:0 sc1
    v_cvt_pk_bf16_f32 v52, v152, v153
    v_cvt_pk_bf16_f32 v53, v154, v155
    v_cvt_pk_bf16_f32 v54, v156, v157
    v_mfma_f32_32x32x16_bf16 v[160:175], v[64:67], v[84:87], v[160:175]
    v_cvt_pk_bf16_f32 v55, v158, v159
    buffer_store_dwordx4 v[52:55], v9, s[12:15], 0 offen offset:640 sc1
    v_cvt_pk_bf16_f32 v32, v208, v209
    v_cvt_pk_bf16_f32 v33, v210, v211
    v_mfma_f32_32x32x16_bf16 v[224:239], v[68:71], v[84:87], v[224:239]
    v_cvt_pk_bf16_f32 v34, v212, v213
    v_cvt_pk_bf16_f32 v35, v214, v215
    buffer_store_dwordx4 v[32:35], v9, s[12:15], 0 offen offset:1280 sc1
    v_cvt_pk_bf16_f32 v36, v216, v217
    v_mfma_f32_32x32x16_bf16 v[160:175], v[72:75], v[88:91], v[160:175]
    v_cvt_pk_bf16_f32 v37, v218, v219
    v_cvt_pk_bf16_f32 v38, v220, v221
    v_cvt_pk_bf16_f32 v39, v222, v223
    buffer_store_dwordx4 v[36:39], v9, s[12:15], 0 offen offset:1920 sc1
    v_mfma_f32_32x32x16_bf16 v[224:239], v[76:79], v[88:91], v[224:239]
    s_waitcnt lgkmcnt(0)
    v_mfma_f32_32x32x16_bf16 v[176:191], v[56:59], v[92:95], v[176:191]
    s_nop 10
    v_cvt_pk_bf16_f32 v40, v160, v161
    v_cvt_pk_bf16_f32 v41, v162, v163
    v_cvt_pk_bf16_f32 v42, v164, v165
    v_cvt_pk_bf16_f32 v43, v166, v167
    v_mfma_f32_32x32x16_bf16 v[240:255], v[60:63], v[92:95], v[240:255]
    buffer_store_dwordx4 v[40:43], v10, s[12:15], 0 offen offset:0 sc1
    v_cvt_pk_bf16_f32 v44, v168, v169
    v_cvt_pk_bf16_f32 v45, v170, v171
    v_cvt_pk_bf16_f32 v46, v172, v173
    v_mfma_f32_32x32x16_bf16 v[176:191], v[64:67], v[96:99], v[176:191]
    v_cvt_pk_bf16_f32 v47, v174, v175
    buffer_store_dwordx4 v[44:47], v10, s[12:15], 0 offen offset:640 sc1
    v_cvt_pk_bf16_f32 v48, v224, v225
    v_cvt_pk_bf16_f32 v49, v226, v227
    v_mfma_f32_32x32x16_bf16 v[240:255], v[68:71], v[96:99], v[240:255]
    v_cvt_pk_bf16_f32 v50, v228, v229
    v_cvt_pk_bf16_f32 v51, v230, v231
    buffer_store_dwordx4 v[48:51], v10, s[12:15], 0 offen offset:1280 sc1
    v_cvt_pk_bf16_f32 v52, v232, v233
    v_mfma_f32_32x32x16_bf16 v[176:191], v[72:75], v[100:103], v[176:191]
    v_cvt_pk_bf16_f32 v53, v234, v235
    v_cvt_pk_bf16_f32 v54, v236, v237
    v_cvt_pk_bf16_f32 v55, v238, v239
    buffer_store_dwordx4 v[52:55], v10, s[12:15], 0 offen offset:1920 sc1
    v_mfma_f32_32x32x16_bf16 v[240:255], v[76:79], v[100:103], v[240:255]
    s_nop 7
    s_nop 3
    v_cvt_pk_bf16_f32 v32, v176, v177
    v_cvt_pk_bf16_f32 v33, v178, v179
    v_cvt_pk_bf16_f32 v34, v180, v181
    v_cvt_pk_bf16_f32 v35, v182, v183
    buffer_store_dwordx4 v[32:35], v11, s[12:15], 0 offen offset:0 sc1
    v_cvt_pk_bf16_f32 v36, v184, v185
    v_cvt_pk_bf16_f32 v37, v186, v187
    v_cvt_pk_bf16_f32 v38, v188, v189
    v_cvt_pk_bf16_f32 v39, v190, v191
    buffer_store_dwordx4 v[36:39], v11, s[12:15], 0 offen offset:640 sc1
    v_cvt_pk_bf16_f32 v40, v240, v241
    v_cvt_pk_bf16_f32 v41, v242, v243
    v_cvt_pk_bf16_f32 v42, v244, v245
    v_cvt_pk_bf16_f32 v43, v246, v247
    buffer_store_dwordx4 v[40:43], v11, s[12:15], 0 offen offset:1280 sc1
    v_cvt_pk_bf16_f32 v44, v248, v249
    v_cvt_pk_bf16_f32 v45, v250, v251
    v_cvt_pk_bf16_f32 v46, v252, v253
    v_cvt_pk_bf16_f32 v47, v254, v255
    buffer_store_dwordx4 v[44:47], v11, s[12:15], 0 offen offset:1920 sc1
    s_branch p2_C
k1_KV:
    s_waitcnt vmcnt(0) lgkmcnt(0)
    v_mfma_f32_32x32x16_bf16 v[128:143], v[32:35], v[40:43], v[128:143]
    ds_read_b128 v[56:59], v17 offset:0
    ds_read_b128 v[60:63], v17 offset:4096
    ds_read_b64_tr_b16 v[80:81], v20 offset:4096
    v_mfma_f32_32x32x16_bf16 v[192:207], v[36:39], v[40:43], v[192:207]
    ds_read_b64_tr_b16 v[82:83], v20 offset:5120
    ds_read_b128 v[64:67], v18 offset:0
    ds_read_b128 v[68:71], v18 offset:4096
    v_mfma_f32_32x32x16_bf16 v[144:159], v[32:35], v[44:47], v[144:159]
    ds_read_b64_tr_b16 v[84:85], v20 offset:8192
    ds_read_b64_tr_b16 v[86:87], v20 offset:9216
    ds_read_b128 v[72:75], v19 offset:0
    v_mfma_f32_32x32x16_bf16 v[208:223], v[36:39], v[44:47], v[208:223]
    ds_read_b128 v[76:79], v19 offset:4096
    ds_read_b64_tr_b16 v[88:89], v20 offset:12288
    ds_read_b64_tr_b16 v[90:91], v20 offset:13312
    v_mfma_f32_32x32x16_bf16 v[160:175], v[32:35], v[48:51], v[160:175]
    ds_read_b64_tr_b16 v[92:93], v21 offset:4096
    ds_read_b64_tr_b16 v[94:95], v21 offset:5120
    ds_read_b64_tr_b16 v[96:97], v21 offset:8192
    v_mfma_f32_32x32x16_bf16 v[224:239], v[36:39], v[48:51], v[224:239]
    ds_read_b64_tr_b16 v[98:99], v21 offset:9216
    ds_read_b64_tr_b16 v[100:101], v21 offset:12288
    ds_read_b64_tr_b16 v[102:103], v21 offset:13312
    v_mfma_f32_32x32x16_bf16 v[176:191], v[32:35], v[52:55], v[176:191]
    v_mfma_f32_32x32x16_bf16 v[240:255], v[36:39], v[52:55], v[240:255]
    s_waitcnt lgkmcnt(6)
    v_mfma_f32_32x32x16_bf16 v[128:143], v[56:59], v[80:83], v[128:143]
    v_mfma_f32_32x32x16_bf16 v[192:207], v[60:63], v[80:83], v[192:207]
    v_mfma_f32_32x32x16_bf16 v[128:143], v[64:67], v[84:87], v[128:143]
    v_mfma_f32_32x32x16_bf16 v[192:207], v[68:71], v[84:87], v[192:207]
    v_mfma_f32_32x32x16_bf16 v[128:143], v[72:75], v[88:91], v[128:143]
    v_mfma_f32_32x32x16_bf16 v[192:207], v[76:79], v[88:91], v[192:207]
    s_waitcnt lgkmcnt(0)
    v_mfma_f32_32x32x16_bf16 v[144:159], v[56:59], v[92:95], v[144:159]
    ds_read_b64_tr_b16 v[80:81], v22 offset:4096
    ds_read_b64_tr_b16 v[82:83], v22 offset:5120
    ds_read_b64_tr_b16 v[84:85], v22 offset:8192
    ds_read_b64_tr_b16 v[86:87], v22 offset:9216
    ds_read_b64_tr_b16 v[88:89], v22 offset:12288
    ds_read_b64_tr_b16 v[90:91], v22 offset:13312
    s_nop 4
    v_pk_mul_f32 v[4:5], v[128:129], s[50:51]
    v_pk_mul_f32 v[6:7], v[130:131], s[50:51]
    v_pk_mul_f32 v[8:9], v[132:133], s[50:51]
    v_pk_mul_f32 v[10:11], v[134:135], s[50:51]
    v_exp_f32_e64 v4, v4 clamp
    v_max_f32 v128, s52, v128
    v_exp_f32_e64 v5, v5 clamp
    v_max_f32 v129, s52, v129
    v_exp_f32_e64 v6, v6 clamp
    v_mfma_f32_32x32x16_bf16 v[208:223], v[60:63], v[92:95], v[208:223]
    v_max_f32 v130, s52, v130
    v_exp_f32_e64 v7, v7 clamp
    v_max_f32 v131, s52, v131
    v_exp_f32_e64 v8, v8 clamp
    v_max_f32 v132, s52, v132
    v_exp_f32_e64 v9, v9 clamp
    v_max_f32 v133, s52, v133
    v_exp_f32_e64 v10, v10 clamp
    v_max_f32 v134, s52, v134
    v_mfma_f32_32x32x16_bf16 v[144:159], v[64:67], v[96:99], v[144:159]
    v_exp_f32_e64 v11, v11 clamp
    v_max_f32 v135, s52, v135
    v_pk_add_f32 v[128:129], v[128:129], v[4:5]
    v_pk_add_f32 v[130:131], v[130:131], v[6:7]
    v_pk_add_f32 v[132:133], v[132:133], v[8:9]
    v_pk_add_f32 v[134:135], v[134:135], v[10:11]
    v_cvt_pk_bf16_f32 v32, v128, v129
    v_cvt_pk_bf16_f32 v33, v130, v131
    v_cvt_pk_bf16_f32 v34, v132, v133
    v_mfma_f32_32x32x16_bf16 v[208:223], v[68:71], v[96:99], v[208:223]
    v_cvt_pk_bf16_f32 v35, v134, v135
    v_pk_mul_f32 v[4:5], v[136:137], s[50:51]
    v_pk_mul_f32 v[6:7], v[138:139], s[50:51]
    v_pk_mul_f32 v[8:9], v[140:141], s[50:51]
    v_pk_mul_f32 v[10:11], v[142:143], s[50:51]
    v_exp_f32_e64 v4, v4 clamp
    v_max_f32 v136, s52, v136
    v_exp_f32_e64 v5, v5 clamp
    v_max_f32 v137, s52, v137
    v_mfma_f32_32x32x16_bf16 v[144:159], v[72:75], v[100:103], v[144:159]
    v_exp_f32_e64 v6, v6 clamp
    v_max_f32 v138, s52, v138
    v_exp_f32_e64 v7, v7 clamp
    v_max_f32 v139, s52, v139
    v_exp_f32_e64 v8, v8 clamp
    v_max_f32 v140, s52, v140
    v_mfma_f32_32x32x16_bf16 v[208:223], v[76:79], v[100:103], v[208:223]
    s_waitcnt lgkmcnt(0)
    v_mfma_f32_32x32x16_bf16 v[160:175], v[56:59], v[80:83], v[160:175]
    ds_read_b64_tr_b16 v[92:93], v23 offset:4096
    ds_read_b64_tr_b16 v[94:95], v23 offset:5120
    ds_read_b64_tr_b16 v[96:97], v23 offset:8192
    ds_read_b64_tr_b16 v[98:99], v23 offset:9216
    ds_read_b64_tr_b16 v[100:101], v23 offset:12288
    ds_read_b64_tr_b16 v[102:103], v23 offset:13312
    s_nop 4
    v_exp_f32_e64 v9, v9 clamp
    v_max_f32 v141, s52, v141
    v_exp_f32_e64 v10, v10 clamp
    v_max_f32 v142, s52, v142
    v_exp_f32_e64 v11, v11 clamp
    v_max_f32 v143, s52, v143
    v_pk_add_f32 v[136:137], v[136:137], v[4:5]
    v_pk_add_f32 v[138:139], v[138:139], v[6:7]
    v_pk_add_f32 v[140:141], v[140:141], v[8:9]
    v_mfma_f32_32x32x16_bf16 v[224:239], v[60:63], v[80:83], v[224:239]
    v_pk_add_f32 v[142:143], v[142:143], v[10:11]
    v_cvt_pk_bf16_f32 v36, v136, v137
    v_cvt_pk_bf16_f32 v37, v138, v139
    v_cvt_pk_bf16_f32 v38, v140, v141
    v_cvt_pk_bf16_f32 v39, v142, v143
    v_pk_mul_f32 v[4:5], v[192:193], s[50:51]
    v_pk_mul_f32 v[6:7], v[194:195], s[50:51]
    v_pk_mul_f32 v[8:9], v[196:197], s[50:51]
    v_pk_mul_f32 v[10:11], v[198:199], s[50:51]
    v_mfma_f32_32x32x16_bf16 v[160:175], v[64:67], v[84:87], v[160:175]
    v_exp_f32_e64 v4, v4 clamp
    v_max_f32 v192, s52, v192
    v_exp_f32_e64 v5, v5 clamp
    v_max_f32 v193, s52, v193
    v_exp_f32_e64 v6, v6 clamp
    v_max_f32 v194, s52, v194
    v_exp_f32_e64 v7, v7 clamp
    v_max_f32 v195, s52, v195
    v_exp_f32_e64 v8, v8 clamp
    v_mfma_f32_32x32x16_bf16 v[224:239], v[68:71], v[84:87], v[224:239]
    v_max_f32 v196, s52, v196
    v_exp_f32_e64 v9, v9 clamp
    v_max_f32 v197, s52, v197
    v_exp_f32_e64 v10, v10 clamp
    v_max_f32 v198, s52, v198
    v_exp_f32_e64 v11, v11 clamp
    v_max_f32 v199, s52, v199
    v_pk_add_f32 v[192:193], v[192:193], v[4:5]
    v_pk_add_f32 v[194:195], v[194:195], v[6:7]
    v_mfma_f32_32x32x16_bf16 v[160:175], v[72:75], v[88:91], v[160:175]
    v_pk_add_f32 v[196:197], v[196:197], v[8:9]
    v_pk_add_f32 v[198:199], v[198:199], v[10:11]
    v_cvt_pk_bf16_f32 v40, v192, v193
    v_cvt_pk_bf16_f32 v41, v194, v195
    v_cvt_pk_bf16_f32 v42, v196, v197
    v_cvt_pk_bf16_f32 v43, v198, v199
    v_mfma_f32_32x32x16_bf16 v[224:239], v[76:79], v[88:91], v[224:239]
    s_waitcnt lgkmcnt(0)
    v_mfma_f32_32x32x16_bf16 v[176:191], v[56:59], v[92:95], v[176:191]
    s_nop 10
    v_pk_mul_f32 v[4:5], v[200:201], s[50:51]
    v_pk_mul_f32 v[6:7], v[202:203], s[50:51]
    v_pk_mul_f32 v[8:9], v[204:205], s[50:51]
    v_pk_mul_f32 v[10:11], v[206:207], s[50:51]
    v_exp_f32_e64 v4, v4 clamp
    v_max_f32 v200, s52, v200
    v_mfma_f32_32x32x16_bf16 v[240:255], v[60:63], v[92:95], v[240:255]
    v_exp_f32_e64 v5, v5 clamp
    v_max_f32 v201, s52, v201
    v_exp_f32_e64 v6, v6 clamp
    v_max_f32 v202, s52, v202
    v_exp_f32_e64 v7, v7 clamp
    v_max_f32 v203, s52, v203
    v_mfma_f32_32x32x16_bf16 v[176:191], v[64:67], v[96:99], v[176:191]
    v_exp_f32_e64 v8, v8 clamp
    v_max_f32 v204, s52, v204
    v_exp_f32_e64 v9, v9 clamp
    v_max_f32 v205, s52, v205
    v_exp_f32_e64 v10, v10 clamp
    v_max_f32 v206, s52, v206
    v_mfma_f32_32x32x16_bf16 v[240:255], v[68:71], v[96:99], v[240:255]
    v_exp_f32_e64 v11, v11 clamp
    v_max_f32 v207, s52, v207
    v_pk_add_f32 v[200:201], v[200:201], v[4:5]
    v_pk_add_f32 v[202:203], v[202:203], v[6:7]
    v_pk_add_f32 v[204:205], v[204:205], v[8:9]
    v_pk_add_f32 v[206:207], v[206:207], v[10:11]
    v_mfma_f32_32x32x16_bf16 v[176:191], v[72:75], v[100:103], v[176:191]
    v_cvt_pk_bf16_f32 v44, v200, v201
    v_cvt_pk_bf16_f32 v45, v202, v203
    v_cvt_pk_bf16_f32 v46, v204, v205
    v_cvt_pk_bf16_f32 v47, v206, v207
    v_mfma_f32_32x32x16_bf16 v[240:255], v[76:79], v[100:103], v[240:255]
    s_nop 7
    s_nop 3
    v_cvt_pk_bf16_f32 v56, v160, v161
    v_cvt_pk_bf16_f32 v57, v162, v163
    v_cvt_pk_bf16_f32 v58, v164, v165
    v_cvt_pk_bf16_f32 v59, v166, v167
    v_cvt_pk_bf16_f32 v60, v168, v169
    v_cvt_pk_bf16_f32 v61, v170, v171
    v_cvt_pk_bf16_f32 v62, v172, v173
    v_cvt_pk_bf16_f32 v63, v174, v175
    v_cvt_pk_bf16_f32 v64, v176, v177
    v_cvt_pk_bf16_f32 v65, v178, v179
    v_cvt_pk_bf16_f32 v66, v180, v181
    v_cvt_pk_bf16_f32 v67, v182, v183
    v_cvt_pk_bf16_f32 v68, v184, v185
    v_cvt_pk_bf16_f32 v69, v186, v187
    v_cvt_pk_bf16_f32 v70, v188, v189
    v_cvt_pk_bf16_f32 v71, v190, v191
    v_cvt_pk_bf16_f32 v72, v224, v225
    v_cvt_pk_bf16_f32 v73, v226, v227
    v_cvt_pk_bf16_f32 v74, v228, v229
    v_cvt_pk_bf16_f32 v75, v230, v231
    v_cvt_pk_bf16_f32 v76, v232, v233
    v_cvt_pk_bf16_f32 v77, v234, v235
    v_cvt_pk_bf16_f32 v78, v236, v237
    v_cvt_pk_bf16_f32 v79, v238, v239
    v_cvt_pk_bf16_f32 v80, v240, v241
    v_cvt_pk_bf16_f32 v81, v242, v243
    v_cvt_pk_bf16_f32 v82, v244, v245
    v_cvt_pk_bf16_f32 v83, v246, v247
    v_cvt_pk_bf16_f32 v84, v248, v249
    v_cvt_pk_bf16_f32 v85, v250, v251
    v_cvt_pk_bf16_f32 v86, v252, v253
    v_cvt_pk_bf16_f32 v87, v254, v255
    s_mov_b32 s56, 0x3f803f80
    s_mov_b32 s57, s56
    s_cmp_lg_u32 s29, 0
    s_cselect_b32 s30, 1, 0x10000000
    s_mov_b32 s31, s30
    s_mov_b64 exec, s[30:31]
    s_cbranch_scc1 k1_ones0
    v_pk_mov_b32 v[64:65], s[56:57], s[56:57]
    v_pk_mov_b32 v[66:67], s[56:57], s[56:57]
    v_pk_mov_b32 v[68:69], s[56:57], s[56:57]
    v_pk_mov_b32 v[70:71], s[56:57], s[56:57]
    v_pk_mov_b32 v[80:81], s[56:57], s[56:57]
    v_pk_mov_b32 v[82:83], s[56:57], s[56:57]
    v_pk_mov_b32 v[84:85], s[56:57], s[56:57]
    v_pk_mov_b32 v[86:87], s[56:57], s[56:57]
    s_branch k1_ones1
k1_ones0:
    v_pk_mov_b32 v[56:57], s[56:57], s[56:57]
    v_pk_mov_b32 v[58:59], s[56:57], s[56:57]
    v_pk_mov_b32 v[60:61], s[56:57], s[56:57]
    v_pk_mov_b32 v[62:63], s[56:57], s[56:57]
    v_pk_mov_b32 v[72:73], s[56:57], s[56:57]
    v_pk_mov_b32 v[74:75], s[56:57], s[56:57]
    v_pk_mov_b32 v[76:77], s[56:57], s[56:57]
    v_pk_mov_b32 v[78:79], s[56:57], s[56:57]
k1_ones1:
    s_mov_b64 exec, -1
    s_nop 0
    v_mfma_f32_32x32x16_bf16 v[160:175], v[32:35], v[56:59], 0
    v_pk_mul_f32 v[4:5], v[144:145], s[50:51]
    v_pk_mul_f32 v[6:7], v[146:147], s[50:51]
    v_pk_mul_f32 v[8:9], v[148:149], s[50:51]
    v_pk_mul_f32 v[10:11], v[150:151], s[50:51]
    v_exp_f32_e64 v4, v4 clamp
    v_max_f32 v144, s52, v144
    v_exp_f32_e64 v5, v5 clamp
    v_mfma_f32_32x32x16_bf16 v[176:191], v[32:35], v[64:67], 0
    v_max_f32 v145, s52, v145
    v_exp_f32_e64 v6, v6 clamp
    v_max_f32 v146, s52, v146
    v_exp_f32_e64 v7, v7 clamp
    v_max_f32 v147, s52, v147
    v_exp_f32_e64 v8, v8 clamp
    v_max_f32 v148, s52, v148
    v_mfma_f32_32x32x16_bf16 v[160:175], v[36:39], v[60:63], v[160:175]
    v_exp_f32_e64 v9, v9 clamp
    v_max_f32 v149, s52, v149
    v_exp_f32_e64 v10, v10 clamp
    v_max_f32 v150, s52, v150
    v_exp_f32_e64 v11, v11 clamp
    v_max_f32 v151, s52, v151
    v_pk_add_f32 v[144:145], v[144:145], v[4:5]
    v_mfma_f32_32x32x16_bf16 v[176:191], v[36:39], v[68:71], v[176:191]
    v_pk_add_f32 v[146:147], v[146:147], v[6:7]
    v_pk_add_f32 v[148:149], v[148:149], v[8:9]
    v_pk_add_f32 v[150:151], v[150:151], v[10:11]
    v_cvt_pk_bf16_f32 v48, v144, v145
    v_cvt_pk_bf16_f32 v49, v146, v147
    v_cvt_pk_bf16_f32 v50, v148, v149
    v_cvt_pk_bf16_f32 v51, v150, v151
    s_nop 1
    v_mfma_f32_32x32x16_bf16 v[224:239], v[48:51], v[56:59], 0
    v_mfma_f32_32x32x16_bf16 v[240:255], v[48:51], v[64:67], 0
    v_mfma_f32_32x32x16_bf16 v[160:175], v[40:43], v[72:75], v[160:175]
    v_pk_mul_f32 v[4:5], v[152:153], s[50:51]
    v_pk_mul_f32 v[6:7], v[154:155], s[50:51]
    v_pk_mul_f32 v[8:9], v[156:157], s[50:51]
    v_pk_mul_f32 v[10:11], v[158:159], s[50:51]
    v_exp_f32_e64 v4, v4 clamp
    v_max_f32 v152, s52, v152
    v_exp_f32_e64 v5, v5 clamp
    v_mfma_f32_32x32x16_bf16 v[176:191], v[40:43], v[80:83], v[176:191]
    v_max_f32 v153, s52, v153
    v_exp_f32_e64 v6, v6 clamp
    v_max_f32 v154, s52, v154
    v_exp_f32_e64 v7, v7 clamp
    v_max_f32 v155, s52, v155
    v_exp_f32_e64 v8, v8 clamp
    v_max_f32 v156, s52, v156
    v_mfma_f32_32x32x16_bf16 v[160:175], v[44:47], v[76:79], v[160:175]
    v_exp_f32_e64 v9, v9 clamp
    v_max_f32 v157, s52, v157
    v_exp_f32_e64 v10, v10 clamp
    v_max_f32 v158, s52, v158
    v_exp_f32_e64 v11, v11 clamp
    v_max_f32 v159, s52, v159
    v_pk_add_f32 v[152:153], v[152:153], v[4:5]
    v_mfma_f32_32x32x16_bf16 v[176:191], v[44:47], v[84:87], v[176:191]
    v_pk_add_f32 v[154:155], v[154:155], v[6:7]
    v_pk_add_f32 v[156:157], v[156:157], v[8:9]
    v_pk_add_f32 v[158:159], v[158:159], v[10:11]
    v_cvt_pk_bf16_f32 v52, v152, v153
    v_cvt_pk_bf16_f32 v53, v154, v155
    v_cvt_pk_bf16_f32 v54, v156, v157
    v_cvt_pk_bf16_f32 v55, v158, v159
    s_nop 1
    v_mfma_f32_32x32x16_bf16 v[224:239], v[52:55], v[60:63], v[224:239]
    v_mfma_f32_32x32x16_bf16 v[240:255], v[52:55], v[68:71], v[240:255]
    v_pk_mul_f32 v[4:5], v[208:209], s[50:51]
    v_pk_mul_f32 v[6:7], v[210:211], s[50:51]
    v_pk_mul_f32 v[8:9], v[212:213], s[50:51]
    v_pk_mul_f32 v[10:11], v[214:215], s[50:51]
    v_exp_f32_e64 v4, v4 clamp
    v_max_f32 v208, s52, v208
    v_exp_f32_e64 v5, v5 clamp
    v_max_f32 v209, s52, v209
    v_exp_f32_e64 v6, v6 clamp
    v_max_f32 v210, s52, v210
    v_exp_f32_e64 v7, v7 clamp
    v_max_f32 v211, s52, v211
    v_exp_f32_e64 v8, v8 clamp
    v_max_f32 v212, s52, v212
    v_exp_f32_e64 v9, v9 clamp
    v_max_f32 v213, s52, v213
    v_exp_f32_e64 v10, v10 clamp
    v_max_f32 v214, s52, v214
    v_exp_f32_e64 v11, v11 clamp
    v_max_f32 v215, s52, v215
    v_pk_add_f32 v[208:209], v[208:209], v[4:5]
    buffer_store_dwordx4 v[160:163], v112, s[12:15], 0 offen sc1
    v_pk_add_f32 v[210:211], v[210:211], v[6:7]
    v_pk_add_f32 v[212:213], v[212:213], v[8:9]
    v_pk_add_f32 v[214:215], v[214:215], v[10:11]
    v_cvt_pk_bf16_f32 v104, v208, v209
    v_cvt_pk_bf16_f32 v105, v210, v211
    v_cvt_pk_bf16_f32 v106, v212, v213
    v_cvt_pk_bf16_f32 v107, v214, v215
    buffer_store_dwordx4 v[164:167], v113, s[12:15], 0 offen sc1
    s_nop 1
    v_mfma_f32_32x32x16_bf16 v[224:239], v[104:107], v[72:75], v[224:239]
    v_mfma_f32_32x32x16_bf16 v[240:255], v[104:107], v[80:83], v[240:255]
    v_pk_mul_f32 v[4:5], v[216:217], s[50:51]
    v_pk_mul_f32 v[6:7], v[218:219], s[50:51]
    v_pk_mul_f32 v[8:9], v[220:221], s[50:51]
    v_pk_mul_f32 v[10:11], v[222:223], s[50:51]
    v_exp_f32_e64 v4, v4 clamp
    v_max_f32 v216, s52, v216
    v_exp_f32_e64 v5, v5 clamp
    buffer_store_dwordx4 v[168:171], v114, s[12:15], 0 offen sc1
    v_max_f32 v217, s52, v217
    v_exp_f32_e64 v6, v6 clamp
    v_max_f32 v218, s52, v218
    v_exp_f32_e64 v7, v7 clamp
    v_max_f32 v219, s52, v219
    v_exp_f32_e64 v8, v8 clamp
    v_max_f32 v220, s52, v220
    buffer_store_dwordx4 v[172:175], v115, s[12:15], 0 offen sc1
    v_exp_f32_e64 v9, v9 clamp
    v_max_f32 v221, s52, v221
    v_exp_f32_e64 v10, v10 clamp
    v_max_f32 v222, s52, v222
    v_exp_f32_e64 v11, v11 clamp
    v_max_f32 v223, s52, v223
    v_pk_add_f32 v[216:217], v[216:217], v[4:5]
    buffer_store_dwordx4 v[176:179], v116, s[12:15], 0 offen sc1
    buffer_store_dwordx4 v[184:187], v118, s[12:15], 0 offen sc1
    v_pk_add_f32 v[218:219], v[218:219], v[6:7]
    v_pk_add_f32 v[220:221], v[220:221], v[8:9]
    v_pk_add_f32 v[222:223], v[222:223], v[10:11]
    v_cvt_pk_bf16_f32 v108, v216, v217
    v_cvt_pk_bf16_f32 v109, v218, v219
    v_cvt_pk_bf16_f32 v110, v220, v221
    v_cvt_pk_bf16_f32 v111, v222, v223
    buffer_store_dwordx4 v[180:183], v117, s[12:15], 0 offen sc1
    buffer_store_dwordx4 v[188:191], v119, s[12:15], 0 offen sc1
    s_nop 1
    v_mfma_f32_32x32x16_bf16 v[224:239], v[108:111], v[76:79], v[224:239]
    v_mfma_f32_32x32x16_bf16 v[240:255], v[108:111], v[84:87], v[240:255]
    s_nop 7
    s_nop 2
    buffer_store_dwordx4 v[224:227], v120, s[12:15], 0 offen sc1
    buffer_store_dwordx4 v[228:231], v121, s[12:15], 0 offen sc1
    buffer_store_dwordx4 v[232:235], v122, s[12:15], 0 offen sc1
    buffer_store_dwordx4 v[236:239], v123, s[12:15], 0 offen sc1
    buffer_store_dwordx4 v[240:243], v124, s[12:15], 0 offen sc1
    buffer_store_dwordx4 v[244:247], v125, s[12:15], 0 offen sc1
    buffer_store_dwordx4 v[248:251], v126, s[12:15], 0 offen sc1
    buffer_store_dwordx4 v[252:255], v127, s[12:15], 0 offen sc1
p2_C:
    s_lshr_b32 s57, s17, 2
    s_and_b32 s58, s17, 3
    s_lshl_b32 s58, s58, 2
    s_and_b32 s59, s18, 3
    s_add_u32 s58, s58, s59
    s_lshr_b32 s59, s18, 2
    s_mov_b32 s4, s98
    s_and_b32 s5, s99, 0xffff
    s_mov_b32 s6, 5242880
    s_mov_b32 s7, 0x20000
    v_and_b32 v1, 63, v0
    v_and_b32 v2, 15, v1
    v_lshrrev_b32 v3, 4, v1
    v_mul_u32_u24 v7, 32768, v3
    v_lshl_add_u32 v164, v2, 4, v7
    v_and_b32 v4, 1, v3
    v_lshlrev_b32 v4, 2, v4
    v_lshl_add_u32 v4, v3, 3, v4
    v_lshrrev_b32 v5, 2, v2
    v_add_u32 v4, v4, v5
    v_xor_b32 v5, 4, v4
    v_and_b32 v6, 3, v2
    v_lshlrev_b32 v6, 3, v6
    v_mul_u32_u24 v4, 160, v4
    v_mul_u32_u24 v5, 160, v5
    v_add_u32 v165, v4, v6
    v_add_u32 v166, v5, v6
    s_mul_i32 s30, s16, 5120
    s_add_u32 s30, s30, 75776
    v_mul_u32_u24 v2, 160, v2
    v_lshl_add_u32 v2, v3, 3, v2
    v_add_u32 v167, s30, v2
    v_lshlrev_b32 v3, 4, v1
    v_add_u32 v168, s30, v3
    s_lshl_b32 s31, s58, 7
    s_lshl_b32 s30, s16, 5
    s_add_u32 s31, s31, s30
    s_lshl_b32 s60, s31, 4
    s_mul_i32 s30, s57, 2752512
    s_add_u32 s60, s60, s30
    s_add_u32 s60, s60, 13762560
    s_mul_i32 s61, s31, 2560
    s_mul_i32 s30, s57, 1280
    s_add_u32 s61, s61, s30
    s_mul_i32 s30, s59, 160
    s_add_u32 s61, s61, s30
    s_mov_b32 s62, 2400
    v_add_u32 v169, 0, v1
    v_mul_u32_u24 v4, 205, v169
    v_lshrrev_b32 v4, 11, v4
    v_lshlrev_b32 v169, 4, v169
    v_mad_u32_u24 v169, v4, s62, v169
    v_add_u32 v170, 64, v1
    v_mul_u32_u24 v4, 205, v170
    v_lshrrev_b32 v4, 11, v4
    v_lshlrev_b32 v170, 4, v170
    v_mad_u32_u24 v170, v4, s62, v170
    v_add_u32 v171, 128, v1
    v_mul_u32_u24 v4, 205, v171
    v_lshrrev_b32 v4, 11, v4
    v_lshlrev_b32 v171, 4, v171
    v_mad_u32_u24 v171, v4, s62, v171
    v_add_u32 v172, 192, v1
    v_mul_u32_u24 v4, 205, v172
    v_lshrrev_b32 v4, 11, v4
    v_lshlrev_b32 v172, 4, v172
    v_mad_u32_u24 v172, v4, s62, v172
    v_add_u32 v173, 256, v1
    v_mul_u32_u24 v4, 205, v173
    v_lshrrev_b32 v4, 11, v4
    v_lshlrev_b32 v173, 4, v173
    v_mad_u32_u24 v173, v4, s62, v173
    v_pk_mov_b32 v[216:217], 0, 0
    v_pk_mov_b32 v[218:219], 0, 0
    v_pk_mov_b32 v[220:221], 0, 0
    v_pk_mov_b32 v[222:223], 0, 0
    v_pk_mov_b32 v[224:225], 0, 0
    v_pk_mov_b32 v[226:227], 0, 0
    v_pk_mov_b32 v[228:229], 0, 0
    v_pk_mov_b32 v[230:231], 0, 0
    v_pk_mov_b32 v[232:233], 0, 0
    v_pk_mov_b32 v[234:235], 0, 0
    v_pk_mov_b32 v[236:237], 0, 0
    v_pk_mov_b32 v[238:239], 0, 0
    v_pk_mov_b32 v[240:241], 0, 0
    v_pk_mov_b32 v[242:243], 0, 0
    v_pk_mov_b32 v[244:245], 0, 0
    v_pk_mov_b32 v[246:247], 0, 0
    v_pk_mov_b32 v[248:249], 0, 0
    v_pk_mov_b32 v[250:251], 0, 0
    v_pk_mov_b32 v[252:253], 0, 0
    v_pk_mov_b32 v[254:255], 0, 0
    v_mov_b32 v174, 63840
    v_mov_b32 v175, 1
    s_sub_u32 s60, s60, 655360
    s_lshl_b32 s20, s17, 2
    s_and_b32 s21, s18, 3
    s_add_u32 s20, s20, s21
    s_lshr_b32 s21, s18, 2
    s_mul_i32 s25, s20, 81920
    s_lshr_b32 s30, s20, 1
    s_mul_i32 s30, s30, 163840
    s_and_b32 s24, s20, 1
    s_mul_i32 s22, s24, 98304
    s_add_u32 s22, s22, s30
    s_lshl_b32 s24, s24, 3
    s_add_u32 s23, s30, s24
    s_add_u32 s23, s23, 65536
    s_mov_b32 s34, -1
    s_mov_b32 s35, 0
    s_mov_b32 s36, 0
    s_mov_b32 s37, -1
    s_mov_b32 s52, 897988541
    s_mov_b32 s53, 0
    s_mov_b32 s67, 0
    v_and_b32 v1, 63, v0
    v_and_b32 v2, 31, v1
    v_lshrrev_b32 v3, 5, v1
    s_and_b32 s30, s16, 3
    s_lshl_b32 s30, s30, 6
    s_lshl_b32 s31, s21, 8
    s_add_u32 s30, s30, s31
    v_add_u32 v4, s30, v2
    v_lshlrev_b32 v13, 4, v4
    v_mul_u32_u24 v12, 32768, v3
    v_add3_u32 v12, s22, v12, v13
    v_add_u32 v13, s23, v13
    v_lshlrev_b32 v8, 4, v2
    v_lshl_add_u32 v8, v3, 12, v8
    v_add_u32 v8, 51200, v8
    v_lshlrev_b32 v9, 4, v1
    s_add_u32 s30, s24, 59392
    v_add_u32 v9, s30, v9
    v_min_u32 v5, 21, v2
    v_cmp_le_u32 vcc, 28, v2
    v_mul_u32_u24 v10, 384, v3
    v_add_u32 v10, 63488, v10
    v_cndmask_b32 v5, v5, 45, vcc
    v_lshl_add_u32 v10, v5, 4, v10
    s_mov_b32 s48, 13762560
    s_lshl_b32 s30, s16, 10
    s_add_u32 s30, s30, 49152
    v_add_u32 v14, s30, v8
    v_lshlrev_b32 v15, 4, v2
    s_add_u32 s30, s30, s24
    s_add_u32 s30, s30, 59392
    v_add_u32 v15, s30, v15
    v_pk_mov_b32 v[20:21], 0, 0
    v_pk_mov_b32 v[22:23], 0, 0
    v_pk_mov_b32 v[28:29], 0, 0
    v_pk_mov_b32 v[30:31], 0, 0
    s_cmp_lt_u32 s70, 16
    s_cbranch_scc0 p2_nodrain
    s_waitcnt vmcnt(0)
p2_nodrain:
    s_barrier
p2_restart:
    v_pk_mov_b32 v[132:133], 0, 0
    v_pk_mov_b32 v[134:135], 0, 0
    v_pk_mov_b32 v[136:137], 0, 0
    v_pk_mov_b32 v[138:139], 0, 0
    v_pk_mov_b32 v[140:141], 0, 0
    v_pk_mov_b32 v[142:143], 0, 0
    v_pk_mov_b32 v[144:145], 0, 0
    v_pk_mov_b32 v[146:147], 0, 0
    v_pk_mov_b32 v[148:149], 0, 0
    v_pk_mov_b32 v[150:151], 0, 0
    v_pk_mov_b32 v[152:153], 0, 0
    v_pk_mov_b32 v[154:155], 0, 0
    v_pk_mov_b32 v[156:157], 0, 0
    v_pk_mov_b32 v[158:159], 0, 0
    v_pk_mov_b32 v[160:161], 0, 0
    v_pk_mov_b32 v[162:163], 0, 0
    v_pk_mov_b32 v[64:65], 0, 0
    v_pk_mov_b32 v[56:57], 0, 0
    v_pk_mov_b32 v[66:67], 0, 0
    v_pk_mov_b32 v[58:59], 0, 0
    s_barrier
    s_cmp_lg_u32 s53, 0
    s_cbranch_scc1 p2_haveq
    ds_read_b128 v[16:19], v14 offset:0
    ds_read_b128 v[24:27], v14 offset:512
    s_mov_b64 exec, s[34:35]
    ds_read_b64 v[20:21], v15 offset:0
    ds_read_b64 v[28:29], v15 offset:512
    s_mov_b64 exec, s[36:37]
    ds_read_b64 v[22:23], v15 offset:0
    ds_read_b64 v[30:31], v15 offset:512
    s_mov_b64 exec, -1
p2_haveq:
    ds_read_b128 v[32:35], v8
    ds_read_b64 v[40:41], v9
    ds_read_b128 v[36:39], v8 offset:512
    ds_read_b64 v[42:43], v9 offset:1024
    ds_read_b128 v[44:47], v10
    ds_read_b128 v[52:55], v10 offset:768
    s_cmp_lg_u32 s53, 0
    s_cbranch_scc1 p2_havemax
    s_waitcnt lgkmcnt(4)
    v_mfma_f32_32x32x16_bf16 v[68:83], v[32:35], v[16:19], 0
    v_mfma_f32_32x32x8_bf16 v[68:83], v[40:41], v[20:21], v[68:83]
    v_mfma_f32_32x32x16_bf16 v[84:99], v[32:35], v[24:27], 0
    v_mfma_f32_32x32x8_bf16 v[84:99], v[40:41], v[28:29], v[84:99]
    s_nop 7
    s_nop 1
    v_max3_f32 v2, v68, v69, v70
    v_max3_f32 v2, v2, v71, v72
    v_max3_f32 v2, v2, v73, v74
    v_max3_f32 v2, v2, v75, v76
    v_max3_f32 v2, v2, v77, v78
    v_max3_f32 v2, v2, v79, v80
    v_max3_f32 v2, v2, v81, v82
    v_max_f32 v2, v2, v83
    v_max3_f32 v3, v84, v85, v86
    v_max3_f32 v3, v3, v87, v88
    v_max3_f32 v3, v3, v89, v90
    v_max3_f32 v3, v3, v91, v92
    v_max3_f32 v3, v3, v93, v94
    v_max3_f32 v3, v3, v95, v96
    v_max3_f32 v3, v3, v97, v98
    v_max_f32 v3, v3, v99
p2_setmax:
    v_mov_b32 v4, v2
    v_mov_b32 v5, v3
    s_nop 1
    v_permlane32_swap_b32 v2, v4
    v_permlane32_swap_b32 v3, v5
    s_nop 1
    v_max_f32 v2, v2, v4
    v_max_f32 v4, v3, v5
    v_sub_f32 v2, 0, v2
    v_sub_f32 v4, 0, v4
    v_mov_b32 v3, v2
    v_mov_b32 v5, v4
    v_pk_mov_b32 v[100:101], v[2:3], v[2:3]
    v_pk_mov_b32 v[102:103], v[2:3], v[2:3]
    v_pk_mov_b32 v[104:105], v[2:3], v[2:3]
    v_pk_mov_b32 v[106:107], v[2:3], v[2:3]
    v_pk_mov_b32 v[108:109], v[2:3], v[2:3]
    v_pk_mov_b32 v[110:111], v[2:3], v[2:3]
    v_pk_mov_b32 v[112:113], v[2:3], v[2:3]
    v_pk_mov_b32 v[114:115], v[2:3], v[2:3]
    v_pk_mov_b32 v[116:117], v[4:5], v[4:5]
    v_pk_mov_b32 v[118:119], v[4:5], v[4:5]
    v_pk_mov_b32 v[120:121], v[4:5], v[4:5]
    v_pk_mov_b32 v[122:123], v[4:5], v[4:5]
    v_pk_mov_b32 v[124:125], v[4:5], v[4:5]
    v_pk_mov_b32 v[126:127], v[4:5], v[4:5]
    v_pk_mov_b32 v[128:129], v[4:5], v[4:5]
    v_pk_mov_b32 v[130:131], v[4:5], v[4:5]
    s_cmp_lg_u32 s53, 0
    s_cbranch_scc1 p2_restart
    v_pk_add_f32 v[68:69], v[68:69], v[2:3]
    v_pk_add_f32 v[70:71], v[70:71], v[2:3]
    v_pk_add_f32 v[72:73], v[72:73], v[2:3]
    v_pk_add_f32 v[74:75], v[74:75], v[2:3]
    v_pk_add_f32 v[76:77], v[76:77], v[2:3]
    v_pk_add_f32 v[78:79], v[78:79], v[2:3]
    v_pk_add_f32 v[80:81], v[80:81], v[2:3]
    v_pk_add_f32 v[82:83], v[82:83], v[2:3]
p2_enter:
    s_mov_b32 s45, 7
    s_mov_b32 s49, 24576
    .p2align 6
p2_loop:
    v_mfma_f32_32x32x16_bf16 v[84:99], v[32:35], v[24:27], v[116:131]
    s_bitcmp1_b32 0x24, s45
    s_cselect_b32 s47, 4294918144, s49
    v_exp_f32 v68, v68
    v_exp_f32 v69, v69
    v_exp_f32 v70, v70
    v_exp_f32 v71, v71
    v_cvt_pk_bf16_f32 v60, v68, v69
    v_cvt_pk_bf16_f32 v61, v70, v71
    v_mfma_f32_32x32x8_bf16 v[84:99], v[40:41], v[28:29], v[84:99]
    v_exp_f32 v72, v72
    v_exp_f32 v73, v73
    v_exp_f32 v74, v74
    v_exp_f32 v75, v75
    v_cvt_pk_bf16_f32 v62, v72, v73
    v_cvt_pk_bf16_f32 v63, v74, v75
    v_mfma_f32_32x32x16_bf16 v[148:163], v[56:59], v[64:67], v[148:163]
    ds_read_b128 v[48:51], v10 offset:1536
    ds_read_b128 v[56:59], v10 offset:2304
    v_exp_f32 v76, v76
    v_exp_f32 v77, v77
    v_exp_f32 v78, v78
    v_exp_f32 v79, v79
    v_cvt_pk_bf16_f32 v64, v76, v77
    v_cvt_pk_bf16_f32 v65, v78, v79
    s_waitcnt lgkmcnt(2)
    v_mfma_f32_32x32x16_bf16 v[132:147], v[44:47], v[60:63], v[132:147]
    v_exp_f32 v80, v80
    v_exp_f32 v81, v81
    v_exp_f32 v82, v82
    v_exp_f32 v83, v83
    v_cvt_pk_bf16_f32 v66, v80, v81
    v_cvt_pk_bf16_f32 v67, v82, v83
    v_mfma_f32_32x32x16_bf16 v[68:83], v[36:39], v[16:19], v[100:115]
    ds_read_b128 v[32:35], v8 offset:1024
    v_exp_f32 v84, v84
    v_exp_f32 v85, v85
    v_exp_f32 v86, v86
    v_exp_f32 v87, v87
    v_cvt_pk_bf16_f32 v60, v84, v85
    v_cvt_pk_bf16_f32 v61, v86, v87
    v_mfma_f32_32x32x8_bf16 v[68:83], v[40:41], v[22:23], v[68:83]
    v_exp_f32 v88, v88
    v_exp_f32 v89, v89
    v_exp_f32 v90, v90
    v_exp_f32 v91, v91
    v_cvt_pk_bf16_f32 v62, v88, v89
    v_cvt_pk_bf16_f32 v63, v90, v91
    v_mfma_f32_32x32x16_bf16 v[132:147], v[52:55], v[64:67], v[132:147]
    v_exp_f32 v92, v92
    v_exp_f32 v93, v93
    v_exp_f32 v94, v94
    v_exp_f32 v95, v95
    v_cvt_pk_bf16_f32 v64, v92, v93
    v_cvt_pk_bf16_f32 v65, v94, v95
    v_mfma_f32_32x32x16_bf16 v[148:163], v[44:47], v[60:63], v[148:163]
    v_exp_f32 v96, v96
    v_exp_f32 v97, v97
    v_exp_f32 v98, v98
    v_exp_f32 v99, v99
    v_cvt_pk_bf16_f32 v66, v96, v97
    v_cvt_pk_bf16_f32 v67, v98, v99
    v_mfma_f32_32x32x16_bf16 v[84:99], v[36:39], v[24:27], v[116:131]
    v_exp_f32 v68, v68
    v_exp_f32 v69, v69
    v_exp_f32 v70, v70
    v_exp_f32 v71, v71
    v_cvt_pk_bf16_f32 v60, v68, v69
    v_cvt_pk_bf16_f32 v61, v70, v71
    v_mfma_f32_32x32x8_bf16 v[84:99], v[40:41], v[30:31], v[84:99]
    v_exp_f32 v72, v72
    v_exp_f32 v73, v73
    v_exp_f32 v74, v74
    v_exp_f32 v75, v75
    v_cvt_pk_bf16_f32 v62, v72, v73
    v_cvt_pk_bf16_f32 v63, v74, v75
    v_mfma_f32_32x32x16_bf16 v[148:163], v[52:55], v[64:67], v[148:163]
    ds_read_b128 v[44:47], v10 offset:3072
    ds_read_b128 v[52:55], v10 offset:3840
    v_exp_f32 v76, v76
    v_exp_f32 v77, v77
    v_exp_f32 v78, v78
    v_exp_f32 v79, v79
    v_cvt_pk_bf16_f32 v64, v76, v77
    v_cvt_pk_bf16_f32 v65, v78, v79
    s_waitcnt lgkmcnt(2)
    v_mfma_f32_32x32x16_bf16 v[132:147], v[48:51], v[60:63], v[132:147]
    v_exp_f32 v80, v80
    v_exp_f32 v81, v81
    v_exp_f32 v82, v82
    v_exp_f32 v83, v83
    v_cvt_pk_bf16_f32 v66, v80, v81
    v_cvt_pk_bf16_f32 v67, v82, v83
    v_mfma_f32_32x32x16_bf16 v[68:83], v[32:35], v[16:19], v[100:115]
    ds_read_b128 v[36:39], v8 offset:1536
    v_exp_f32 v84, v84
    v_exp_f32 v85, v85
    v_exp_f32 v86, v86
    v_exp_f32 v87, v87
    v_cvt_pk_bf16_f32 v60, v84, v85
    v_cvt_pk_bf16_f32 v61, v86, v87
    v_mfma_f32_32x32x8_bf16 v[68:83], v[42:43], v[20:21], v[68:83]
    ds_read_b64 v[40:41], v9 offset:2048
    v_exp_f32 v88, v88
    v_exp_f32 v89, v89
    v_exp_f32 v90, v90
    v_exp_f32 v91, v91
    v_cvt_pk_bf16_f32 v62, v88, v89
    v_cvt_pk_bf16_f32 v63, v90, v91
    v_mfma_f32_32x32x16_bf16 v[132:147], v[56:59], v[64:67], v[132:147]
    v_exp_f32 v92, v92
    v_exp_f32 v93, v93
    v_exp_f32 v94, v94
    v_exp_f32 v95, v95
    v_cvt_pk_bf16_f32 v64, v92, v93
    v_cvt_pk_bf16_f32 v65, v94, v95
    v_mfma_f32_32x32x16_bf16 v[148:163], v[48:51], v[60:63], v[148:163]
    v_exp_f32 v96, v96
    v_exp_f32 v97, v97
    v_exp_f32 v98, v98
    v_exp_f32 v99, v99
    v_cvt_pk_bf16_f32 v66, v96, v97
    v_cvt_pk_bf16_f32 v67, v98, v99
    v_mfma_f32_32x32x16_bf16 v[84:99], v[32:35], v[24:27], v[116:131]
    v_exp_f32 v68, v68
    v_exp_f32 v69, v69
    v_exp_f32 v70, v70
    v_exp_f32 v71, v71
    v_cvt_pk_bf16_f32 v60, v68, v69
    v_cvt_pk_bf16_f32 v61, v70, v71
    v_mfma_f32_32x32x8_bf16 v[84:99], v[42:43], v[28:29], v[84:99]
    v_exp_f32 v72, v72
    v_exp_f32 v73, v73
    v_exp_f32 v74, v74
    v_exp_f32 v75, v75
    v_cvt_pk_bf16_f32 v62, v72, v73
    v_cvt_pk_bf16_f32 v63, v74, v75
    v_mfma_f32_32x32x16_bf16 v[148:163], v[56:59], v[64:67], v[148:163]
    ds_read_b128 v[48:51], v10 offset:4608
    ds_read_b128 v[56:59], v10 offset:5376
    v_exp_f32 v76, v76
    v_exp_f32 v77, v77
    v_exp_f32 v78, v78
    v_exp_f32 v79, v79
    v_cvt_pk_bf16_f32 v64, v76, v77
    v_cvt_pk_bf16_f32 v65, v78, v79
    s_waitcnt lgkmcnt(2)
    v_mfma_f32_32x32x16_bf16 v[132:147], v[44:47], v[60:63], v[132:147]
    v_exp_f32 v80, v80
    v_exp_f32 v81, v81
    v_exp_f32 v82, v82
    v_exp_f32 v83, v83
    v_cvt_pk_bf16_f32 v66, v80, v81
    v_cvt_pk_bf16_f32 v67, v82, v83
    v_mfma_f32_32x32x16_bf16 v[68:83], v[36:39], v[16:19], v[100:115]
    ds_read_b128 v[32:35], v8 offset:2048
    v_exp_f32 v84, v84
    v_exp_f32 v85, v85
    v_exp_f32 v86, v86
    v_exp_f32 v87, v87
    v_cvt_pk_bf16_f32 v60, v84, v85
    v_cvt_pk_bf16_f32 v61, v86, v87
    v_mfma_f32_32x32x8_bf16 v[68:83], v[42:43], v[22:23], v[68:83]
    v_exp_f32 v88, v88
    v_exp_f32 v89, v89
    v_exp_f32 v90, v90
    v_exp_f32 v91, v91
    v_cvt_pk_bf16_f32 v62, v88, v89
    v_cvt_pk_bf16_f32 v63, v90, v91
    v_mfma_f32_32x32x16_bf16 v[132:147], v[52:55], v[64:67], v[132:147]
    v_exp_f32 v92, v92
    v_exp_f32 v93, v93
    v_exp_f32 v94, v94
    v_exp_f32 v95, v95
    v_cvt_pk_bf16_f32 v64, v92, v93
    v_cvt_pk_bf16_f32 v65, v94, v95
    v_mfma_f32_32x32x16_bf16 v[148:163], v[44:47], v[60:63], v[148:163]
    v_exp_f32 v96, v96
    v_exp_f32 v97, v97
    v_exp_f32 v98, v98
    v_exp_f32 v99, v99
    v_cvt_pk_bf16_f32 v66, v96, v97
    v_cvt_pk_bf16_f32 v67, v98, v99
    v_mfma_f32_32x32x16_bf16 v[84:99], v[36:39], v[24:27], v[116:131]
    v_exp_f32 v68, v68
    v_exp_f32 v69, v69
    v_exp_f32 v70, v70
    v_exp_f32 v71, v71
    v_cvt_pk_bf16_f32 v60, v68, v69
    v_cvt_pk_bf16_f32 v61, v70, v71
    v_mfma_f32_32x32x8_bf16 v[84:99], v[42:43], v[30:31], v[84:99]
    v_exp_f32 v72, v72
    v_exp_f32 v73, v73
    v_exp_f32 v74, v74
    v_exp_f32 v75, v75
    v_cvt_pk_bf16_f32 v62, v72, v73
    v_cvt_pk_bf16_f32 v63, v74, v75
    v_mfma_f32_32x32x16_bf16 v[148:163], v[52:55], v[64:67], v[148:163]
    ds_read_b128 v[44:47], v10 offset:6144
    ds_read_b128 v[52:55], v10 offset:6912
    v_exp_f32 v76, v76
    v_exp_f32 v77, v77
    v_exp_f32 v78, v78
    v_exp_f32 v79, v79
    v_cvt_pk_bf16_f32 v64, v76, v77
    v_cvt_pk_bf16_f32 v65, v78, v79
    s_waitcnt lgkmcnt(2)
    v_mfma_f32_32x32x16_bf16 v[132:147], v[48:51], v[60:63], v[132:147]
    v_exp_f32 v80, v80
    v_exp_f32 v81, v81
    v_exp_f32 v82, v82
    v_exp_f32 v83, v83
    v_cvt_pk_bf16_f32 v66, v80, v81
    v_cvt_pk_bf16_f32 v67, v82, v83
    v_mfma_f32_32x32x16_bf16 v[68:83], v[32:35], v[16:19], v[100:115]
    ds_read_b128 v[36:39], v8 offset:2560
    v_exp_f32 v84, v84
    v_exp_f32 v85, v85
    v_exp_f32 v86, v86
    v_exp_f32 v87, v87
    v_cvt_pk_bf16_f32 v60, v84, v85
    v_cvt_pk_bf16_f32 v61, v86, v87
    v_mfma_f32_32x32x8_bf16 v[68:83], v[40:41], v[20:21], v[68:83]
    ds_read_b64 v[42:43], v9 offset:3072
    v_exp_f32 v88, v88
    v_exp_f32 v89, v89
    v_exp_f32 v90, v90
    v_exp_f32 v91, v91
    v_cvt_pk_bf16_f32 v62, v88, v89
    v_cvt_pk_bf16_f32 v63, v90, v91
    v_mfma_f32_32x32x16_bf16 v[132:147], v[56:59], v[64:67], v[132:147]
    v_exp_f32 v92, v92
    v_exp_f32 v93, v93
    v_exp_f32 v94, v94
    v_exp_f32 v95, v95
    v_cvt_pk_bf16_f32 v64, v92, v93
    v_cvt_pk_bf16_f32 v65, v94, v95
    v_mfma_f32_32x32x16_bf16 v[148:163], v[48:51], v[60:63], v[148:163]
    v_exp_f32 v96, v96
    v_exp_f32 v97, v97
    v_exp_f32 v98, v98
    v_exp_f32 v99, v99
    v_cvt_pk_bf16_f32 v66, v96, v97
    v_cvt_pk_bf16_f32 v67, v98, v99
    v_mfma_f32_32x32x16_bf16 v[84:99], v[32:35], v[24:27], v[116:131]
    v_exp_f32 v68, v68
    v_exp_f32 v69, v69
    v_exp_f32 v70, v70
    v_exp_f32 v71, v71
    v_cvt_pk_bf16_f32 v60, v68, v69
    v_cvt_pk_bf16_f32 v61, v70, v71
    v_mfma_f32_32x32x8_bf16 v[84:99], v[40:41], v[28:29], v[84:99]
    v_exp_f32 v72, v72
    v_exp_f32 v73, v73
    v_exp_f32 v74, v74
    v_exp_f32 v75, v75
    v_cvt_pk_bf16_f32 v62, v72, v73
    v_cvt_pk_bf16_f32 v63, v74, v75
    v_mfma_f32_32x32x16_bf16 v[148:163], v[56:59], v[64:67], v[148:163]
    ds_read_b128 v[48:51], v10 offset:7680
    ds_read_b128 v[56:59], v10 offset:8448
    v_exp_f32 v76, v76
    v_exp_f32 v77, v77
    v_exp_f32 v78, v78
    v_exp_f32 v79, v79
    v_cvt_pk_bf16_f32 v64, v76, v77
    v_cvt_pk_bf16_f32 v65, v78, v79
    s_waitcnt lgkmcnt(2)
    v_mfma_f32_32x32x16_bf16 v[132:147], v[44:47], v[60:63], v[132:147]
    v_exp_f32 v80, v80
    v_exp_f32 v81, v81
    v_exp_f32 v82, v82
    v_exp_f32 v83, v83
    v_cvt_pk_bf16_f32 v66, v80, v81
    v_cvt_pk_bf16_f32 v67, v82, v83
    v_mfma_f32_32x32x16_bf16 v[68:83], v[36:39], v[16:19], v[100:115]
    ds_read_b128 v[32:35], v8 offset:3072
    v_exp_f32 v84, v84
    v_exp_f32 v85, v85
    v_exp_f32 v86, v86
    v_exp_f32 v87, v87
    v_cvt_pk_bf16_f32 v60, v84, v85
    v_cvt_pk_bf16_f32 v61, v86, v87
    v_mfma_f32_32x32x8_bf16 v[68:83], v[40:41], v[22:23], v[68:83]
    v_exp_f32 v88, v88
    v_exp_f32 v89, v89
    v_exp_f32 v90, v90
    v_exp_f32 v91, v91
    v_cvt_pk_bf16_f32 v62, v88, v89
    v_cvt_pk_bf16_f32 v63, v90, v91
    v_mfma_f32_32x32x16_bf16 v[132:147], v[52:55], v[64:67], v[132:147]
    v_exp_f32 v92, v92
    v_exp_f32 v93, v93
    v_exp_f32 v94, v94
    v_exp_f32 v95, v95
    v_cvt_pk_bf16_f32 v64, v92, v93
    v_cvt_pk_bf16_f32 v65, v94, v95
    v_mfma_f32_32x32x16_bf16 v[148:163], v[44:47], v[60:63], v[148:163]
    v_exp_f32 v96, v96
    v_exp_f32 v97, v97
    v_exp_f32 v98, v98
    v_exp_f32 v99, v99
    v_cvt_pk_bf16_f32 v66, v96, v97
    v_cvt_pk_bf16_f32 v67, v98, v99
    v_mfma_f32_32x32x16_bf16 v[84:99], v[36:39], v[24:27], v[116:131]
    v_exp_f32 v68, v68
    v_exp_f32 v69, v69
    v_exp_f32 v70, v70
    v_exp_f32 v71, v71
    v_cvt_pk_bf16_f32 v60, v68, v69
    v_cvt_pk_bf16_f32 v61, v70, v71
    v_mfma_f32_32x32x8_bf16 v[84:99], v[40:41], v[30:31], v[84:99]
    v_exp_f32 v72, v72
    v_exp_f32 v73, v73
    v_exp_f32 v74, v74
    v_exp_f32 v75, v75
    v_cvt_pk_bf16_f32 v62, v72, v73
    v_cvt_pk_bf16_f32 v63, v74, v75
    v_mfma_f32_32x32x16_bf16 v[148:163], v[52:55], v[64:67], v[148:163]
    ds_read_b128 v[44:47], v10 offset:9216
    ds_read_b128 v[52:55], v10 offset:9984
    v_exp_f32 v76, v76
    v_exp_f32 v77, v77
    v_exp_f32 v78, v78
    v_exp_f32 v79, v79
    v_cvt_pk_bf16_f32 v64, v76, v77
    v_cvt_pk_bf16_f32 v65, v78, v79
    s_waitcnt vmcnt(0) lgkmcnt(2)
    v_mfma_f32_32x32x16_bf16 v[132:147], v[48:51], v[60:63], v[132:147]
    v_exp_f32 v80, v80
    v_exp_f32 v81, v81
    v_exp_f32 v82, v82
    v_exp_f32 v83, v83
    v_cvt_pk_bf16_f32 v66, v80, v81
    v_cvt_pk_bf16_f32 v67, v82, v83
    v_mfma_f32_32x32x16_bf16 v[68:83], v[32:35], v[16:19], v[100:115]
    s_barrier
    v_add_u32 v9, s47, v9
    ds_read_b128 v[36:39], v8 offset:3584
    v_exp_f32 v84, v84
    v_exp_f32 v85, v85
    v_exp_f32 v86, v86
    v_exp_f32 v87, v87
    v_cvt_pk_bf16_f32 v60, v84, v85
    v_cvt_pk_bf16_f32 v61, v86, v87
    v_mfma_f32_32x32x8_bf16 v[68:83], v[42:43], v[20:21], v[68:83]
    ds_read_b64 v[40:41], v9 offset:0
    v_exp_f32 v88, v88
    v_exp_f32 v89, v89
    v_exp_f32 v90, v90
    v_exp_f32 v91, v91
    v_cvt_pk_bf16_f32 v62, v88, v89
    v_cvt_pk_bf16_f32 v63, v90, v91
    v_mfma_f32_32x32x16_bf16 v[132:147], v[56:59], v[64:67], v[132:147]
    v_exp_f32 v92, v92
    v_exp_f32 v93, v93
    v_exp_f32 v94, v94
    v_exp_f32 v95, v95
    v_cvt_pk_bf16_f32 v64, v92, v93
    v_cvt_pk_bf16_f32 v65, v94, v95
    v_mfma_f32_32x32x16_bf16 v[148:163], v[48:51], v[60:63], v[148:163]
    v_exp_f32 v96, v96
    v_exp_f32 v97, v97
    v_exp_f32 v98, v98
    v_exp_f32 v99, v99
    v_cvt_pk_bf16_f32 v66, v96, v97
    v_cvt_pk_bf16_f32 v67, v98, v99
    v_mfma_f32_32x32x16_bf16 v[84:99], v[32:35], v[24:27], v[116:131]
    v_exp_f32 v68, v68
    v_exp_f32 v69, v69
    v_exp_f32 v70, v70
    v_exp_f32 v71, v71
    v_cvt_pk_bf16_f32 v60, v68, v69
    v_cvt_pk_bf16_f32 v61, v70, v71
    v_mfma_f32_32x32x8_bf16 v[84:99], v[42:43], v[28:29], v[84:99]
    v_exp_f32 v72, v72
    v_exp_f32 v73, v73
    v_exp_f32 v74, v74
    v_exp_f32 v75, v75
    v_cvt_pk_bf16_f32 v62, v72, v73
    v_cvt_pk_bf16_f32 v63, v74, v75
    v_mfma_f32_32x32x16_bf16 v[148:163], v[56:59], v[64:67], v[148:163]
    ds_read_b128 v[48:51], v10 offset:10752
    ds_read_b128 v[56:59], v10 offset:11520
    v_exp_f32 v76, v76
    v_exp_f32 v77, v77
    v_exp_f32 v78, v78
    v_exp_f32 v79, v79
    v_cvt_pk_bf16_f32 v64, v76, v77
    v_cvt_pk_bf16_f32 v65, v78, v79
    s_waitcnt lgkmcnt(2)
    v_mfma_f32_32x32x16_bf16 v[132:147], v[44:47], v[60:63], v[132:147]
    v_exp_f32 v80, v80
    v_exp_f32 v81, v81
    v_exp_f32 v82, v82
    v_exp_f32 v83, v83
    v_cvt_pk_bf16_f32 v66, v80, v81
    v_cvt_pk_bf16_f32 v67, v82, v83
    v_mfma_f32_32x32x16_bf16 v[68:83], v[36:39], v[16:19], v[100:115]
    v_add_u32 v8, s47, v8
    ds_read_b128 v[32:35], v8 offset:0
    v_exp_f32 v84, v84
    v_exp_f32 v85, v85
    v_exp_f32 v86, v86
    v_exp_f32 v87, v87
    v_cvt_pk_bf16_f32 v60, v84, v85
    v_cvt_pk_bf16_f32 v61, v86, v87
    v_mfma_f32_32x32x8_bf16 v[68:83], v[42:43], v[22:23], v[68:83]
    v_exp_f32 v88, v88
    v_exp_f32 v89, v89
    v_exp_f32 v90, v90
    v_exp_f32 v91, v91
    v_cvt_pk_bf16_f32 v62, v88, v89
    v_cvt_pk_bf16_f32 v63, v90, v91
    v_mfma_f32_32x32x16_bf16 v[132:147], v[52:55], v[64:67], v[132:147]
    v_exp_f32 v92, v92
    v_exp_f32 v93, v93
    v_exp_f32 v94, v94
    v_exp_f32 v95, v95
    v_cvt_pk_bf16_f32 v64, v92, v93
    v_cvt_pk_bf16_f32 v65, v94, v95
    v_mfma_f32_32x32x16_bf16 v[148:163], v[44:47], v[60:63], v[148:163]
    v_exp_f32 v96, v96
    v_exp_f32 v97, v97
    v_exp_f32 v98, v98
    v_exp_f32 v99, v99
    v_cvt_pk_bf16_f32 v66, v96, v97
    v_cvt_pk_bf16_f32 v67, v98, v99
    v_mfma_f32_32x32x16_bf16 v[84:99], v[36:39], v[24:27], v[116:131]
    v_add_u32 v10, s47, v10
    v_exp_f32 v68, v68
    v_exp_f32 v69, v69
    v_exp_f32 v70, v70
    v_exp_f32 v71, v71
    v_cvt_pk_bf16_f32 v60, v68, v69
    v_cvt_pk_bf16_f32 v61, v70, v71
    v_mfma_f32_32x32x8_bf16 v[84:99], v[42:43], v[30:31], v[84:99]
    v_exp_f32 v72, v72
    v_exp_f32 v73, v73
    v_exp_f32 v74, v74
    v_exp_f32 v75, v75
    v_cvt_pk_bf16_f32 v62, v72, v73
    v_cvt_pk_bf16_f32 v63, v74, v75
    v_mfma_f32_32x32x16_bf16 v[148:163], v[52:55], v[64:67], v[148:163]
    ds_read_b128 v[44:47], v10 offset:0
    ds_read_b128 v[52:55], v10 offset:768
    v_exp_f32 v76, v76
    v_exp_f32 v77, v77
    v_exp_f32 v78, v78
    v_exp_f32 v79, v79
    v_cvt_pk_bf16_f32 v64, v76, v77
    v_cvt_pk_bf16_f32 v65, v78, v79
    s_waitcnt lgkmcnt(2)
    v_mfma_f32_32x32x16_bf16 v[132:147], v[48:51], v[60:63], v[132:147]
    v_exp_f32 v80, v80
    v_exp_f32 v81, v81
    v_exp_f32 v82, v82
    v_exp_f32 v83, v83
    v_cvt_pk_bf16_f32 v66, v80, v81
    v_cvt_pk_bf16_f32 v67, v82, v83
    v_mfma_f32_32x32x16_bf16 v[68:83], v[32:35], v[16:19], v[100:115]
    ds_read_b128 v[36:39], v8 offset:512
    v_exp_f32 v84, v84
    v_exp_f32 v85, v85
    v_exp_f32 v86, v86
    v_exp_f32 v87, v87
    v_cvt_pk_bf16_f32 v60, v84, v85
    v_cvt_pk_bf16_f32 v61, v86, v87
    v_mfma_f32_32x32x8_bf16 v[68:83], v[40:41], v[20:21], v[68:83]
    ds_read_b64 v[42:43], v9 offset:1024
    v_exp_f32 v88, v88
    v_exp_f32 v89, v89
    v_exp_f32 v90, v90
    v_exp_f32 v91, v91
    v_cvt_pk_bf16_f32 v62, v88, v89
    v_cvt_pk_bf16_f32 v63, v90, v91
    v_mfma_f32_32x32x16_bf16 v[132:147], v[56:59], v[64:67], v[132:147]
    v_exp_f32 v92, v92
    v_exp_f32 v93, v93
    v_exp_f32 v94, v94
    v_exp_f32 v95, v95
    v_cvt_pk_bf16_f32 v64, v92, v93
    v_cvt_pk_bf16_f32 v65, v94, v95
    v_mfma_f32_32x32x16_bf16 v[148:163], v[48:51], v[60:63], v[148:163]
    s_sub_u32 s45, s45, 1
    v_exp_f32 v96, v96
    v_exp_f32 v97, v97
    v_exp_f32 v98, v98
    v_exp_f32 v99, v99
    v_cvt_pk_bf16_f32 v66, v96, v97
    v_cvt_pk_bf16_f32 v67, v98, v99
    s_cbranch_scc0 p2_loop
    s_nop 0
    v_mfma_f32_32x32x16_bf16 v[148:163], v[56:59], v[64:67], v[148:163]
    v_subrev_u32 v8, 49152, v8
    v_subrev_u32 v9, 49152, v9
    v_subrev_u32 v10, 49152, v10
    s_mov_b32 s30, 1400897536
    s_waitcnt lgkmcnt(0)
    v_mov_b32 v2, v140
    v_mov_b32 v5, v140
    s_nop 1
    v_permlane32_swap_b32 v2, v5
    s_nop 0
    v_rcp_f32 v4, v5
    s_nop 0
    v_pk_mul_f32 v[132:133], v[132:133], v[4:5] op_sel_hi:[1,0]
    v_pk_mul_f32 v[134:135], v[134:135], v[4:5] op_sel_hi:[1,0]
    v_pk_mul_f32 v[136:137], v[136:137], v[4:5] op_sel_hi:[1,0]
    v_pk_mul_f32 v[138:139], v[138:139], v[4:5] op_sel_hi:[1,0]
    v_pk_mul_f32 v[140:141], v[140:141], v[4:5] op_sel_hi:[1,0]
    v_pk_mul_f32 v[142:143], v[142:143], v[4:5] op_sel_hi:[1,0]
    v_cvt_pk_bf16_f32 v132, v132, v133
    v_cvt_pk_bf16_f32 v133, v134, v135
    v_cvt_pk_bf16_f32 v134, v136, v137
    v_cvt_pk_bf16_f32 v135, v138, v139
    v_cvt_pk_bf16_f32 v136, v140, v141
    v_cvt_pk_bf16_f32 v137, v142, v143
    s_mov_b64 exec, s[34:35]
    buffer_store_dwordx2 v[136:137], v13, s[12:15], s48 offen offset:0 sc1
    s_mov_b64 exec, -1
    v_permlane32_swap_b32 v132, v134
    v_permlane32_swap_b32 v133, v135
    buffer_store_dwordx4 v[132:135], v12, s[12:15], s48 offen offset:0 sc1
    v_mov_b32 v2, v156
    v_mov_b32 v3, v156
    s_nop 1
    v_permlane32_swap_b32 v2, v3
    s_nop 0
    v_rcp_f32 v4, v3
    s_nop 0
    v_pk_mul_f32 v[148:149], v[148:149], v[4:5] op_sel_hi:[1,0]
    v_pk_mul_f32 v[150:151], v[150:151], v[4:5] op_sel_hi:[1,0]
    v_pk_mul_f32 v[152:153], v[152:153], v[4:5] op_sel_hi:[1,0]
    v_pk_mul_f32 v[154:155], v[154:155], v[4:5] op_sel_hi:[1,0]
    v_pk_mul_f32 v[156:157], v[156:157], v[4:5] op_sel_hi:[1,0]
    v_pk_mul_f32 v[158:159], v[158:159], v[4:5] op_sel_hi:[1,0]
    v_cvt_pk_bf16_f32 v148, v148, v149
    v_cvt_pk_bf16_f32 v149, v150, v151
    v_cvt_pk_bf16_f32 v150, v152, v153
    v_cvt_pk_bf16_f32 v151, v154, v155
    v_cvt_pk_bf16_f32 v152, v156, v157
    v_cvt_pk_bf16_f32 v153, v158, v159
    s_mov_b64 exec, s[34:35]
    buffer_store_dwordx2 v[152:153], v13, s[12:15], s48 offen offset:512 sc1
    s_mov_b64 exec, -1
    v_permlane32_swap_b32 v148, v150
    v_permlane32_swap_b32 v149, v151
    buffer_store_dwordx4 v[148:151], v12, s[12:15], s48 offen offset:512 sc1
    v_cmp_nle_f32 vcc, v3, s30
    v_cmp_nle_f32 s[40:41], v5, s30
    s_nop 1
    s_or_b64 vcc, vcc, s[40:41]
    s_cmp_eq_u64 vcc, 0
    s_cselect_b32 s30, 1, 257
    v_mov_b32 v7, s30
    s_mov_b64 exec, 1
    ds_add_u32 v174, v7
    s_mov_b64 exec, -1
    s_lshl_b32 s40, 8, s53
p3_v:
    ds_read_b32 v96, v174
    s_waitcnt lgkmcnt(0)
    v_readfirstlane_b32 s41, v96
    s_nop 0
    s_and_b32 s42, s41, 255
    s_cmp_lt_u32 s42, s40
    s_cbranch_scc1 p3_v
    s_lshr_b32 s41, s41, 8
    s_andn2_b32 s41, s41, s67
    s_cmp_lg_u32 s41, 0
    s_cbranch_scc1 p2_fallback
    ds_read_b32 v96, v174 offset:16
    s_waitcnt lgkmcnt(0)
    v_readfirstlane_b32 s30, v96
    s_mov_b32 s43, 0
    s_nop 1
    s_cmp_lg_u32 s30, 0
    s_cbranch_scc1 p3_f0
    s_waitcnt vmcnt(0)
    s_mov_b64 exec, 1
    ds_add_u32 v174, v175 offset:4
    s_mov_b64 exec, -1
    s_mov_b32 s43, 1
p3_w0:
    ds_read_b32 v96, v174 offset:16
    s_waitcnt lgkmcnt(0)
    v_readfirstlane_b32 s30, v96
    s_sleep 1
    s_cmp_eq_u32 s30, 0
    s_cbranch_scc1 p3_w0
p3_f0:
    s_mul_i32 s31, s30, 655360
    s_add_u32 s45, s60, s31
    s_cmp_eq_u32 s30, 0
    s_cselect_b32 s45, 0x40000000, s45
    s_cmp_eq_u32 s30, 2
    s_cselect_b32 s31, 25600, 0
    s_cmp_eq_u32 s30, 3
    s_cselect_b32 s31, 125952, s31
    s_cmp_eq_u32 s30, 4
    s_cselect_b32 s31, 100352, s31
    v_add_u32 v100, s31, v165
    v_add_u32 v101, s31, v166
    buffer_load_dwordx4 v[16:19], v164, s[12:15], s45 offen sc1
    buffer_load_dwordx4 v[20:23], v164, s[12:15], s45 offen offset:256 sc1
    s_add_u32 s45, s45, 131072
    buffer_load_dwordx4 v[24:27], v164, s[12:15], s45 offen sc1
    buffer_load_dwordx4 v[28:31], v164, s[12:15], s45 offen offset:256 sc1
    s_add_u32 s45, s45, 131072
    buffer_load_dwordx4 v[32:35], v164, s[12:15], s45 offen sc1
    buffer_load_dwordx4 v[36:39], v164, s[12:15], s45 offen offset:256 sc1
    s_add_u32 s45, s45, 131072
    buffer_load_dwordx4 v[40:43], v164, s[12:15], s45 offen sc1
    buffer_load_dwordx4 v[44:47], v164, s[12:15], s45 offen offset:256 sc1
    s_add_u32 s45, s45, 131072
    buffer_load_dwordx4 v[48:51], v164, s[12:15], s45 offen sc1
    buffer_load_dwordx4 v[52:55], v164, s[12:15], s45 offen offset:256 sc1
    s_add_u32 s45, s45, 131072
    ds_read_b64_tr_b16 v[176:177], v100 offset:0
    ds_read_b64_tr_b16 v[178:179], v101 offset:0
    ds_read_b64_tr_b16 v[180:181], v100 offset:32
    ds_read_b64_tr_b16 v[182:183], v101 offset:32
    ds_read_b64_tr_b16 v[184:185], v100 offset:64
    ds_read_b64_tr_b16 v[186:187], v101 offset:64
    ds_read_b64_tr_b16 v[188:189], v100 offset:96
    ds_read_b64_tr_b16 v[190:191], v101 offset:96
    ds_read_b64_tr_b16 v[192:193], v100 offset:128
    ds_read_b64_tr_b16 v[194:195], v101 offset:128
p3_b0:
    ds_read_b32 v96, v174 offset:20
    s_waitcnt vmcnt(8) lgkmcnt(0)
    v_readfirstlane_b32 s30, v96
    s_nop 0
    s_cmp_lg_u32 s43, 0
    s_cbranch_scc1 p3_dd
    s_mov_b64 exec, 1
    ds_add_u32 v174, v175 offset:4
    s_mov_b64 exec, -1
p3_dd:
    v_mfma_f32_16x16x32_bf16 v[216:219], v[176:179], v[16:19], v[216:219]
    ds_read_b64_tr_b16 v[196:197], v100 offset:5120
    ds_read_b64_tr_b16 v[198:199], v101 offset:5120
    v_mfma_f32_16x16x32_bf16 v[236:239], v[176:179], v[20:23], v[236:239]
    ds_read_b64_tr_b16 v[200:201], v100 offset:5152
    ds_read_b64_tr_b16 v[202:203], v101 offset:5152
    v_mfma_f32_16x16x32_bf16 v[220:223], v[180:183], v[16:19], v[220:223]
    ds_read_b64_tr_b16 v[204:205], v100 offset:5184
    ds_read_b64_tr_b16 v[206:207], v101 offset:5184
    v_mfma_f32_16x16x32_bf16 v[240:243], v[180:183], v[20:23], v[240:243]
    ds_read_b64_tr_b16 v[208:209], v100 offset:5216
    ds_read_b64_tr_b16 v[210:211], v101 offset:5216
    v_mfma_f32_16x16x32_bf16 v[224:227], v[184:187], v[16:19], v[224:227]
    ds_read_b64_tr_b16 v[212:213], v100 offset:5248
    ds_read_b64_tr_b16 v[214:215], v101 offset:5248
    s_mul_i32 s31, s30, 655360
    s_add_u32 s45, s60, s31
    s_cmp_eq_u32 s30, 0
    s_cselect_b32 s45, 0x40000000, s45
    s_cmp_eq_u32 s30, 2
    s_cselect_b32 s31, 25600, 0
    s_cmp_eq_u32 s30, 3
    s_cselect_b32 s31, 125952, s31
    s_cmp_eq_u32 s30, 4
    s_cselect_b32 s31, 100352, s31
    v_add_u32 v102, s31, v165
    v_add_u32 v103, s31, v166
    v_mfma_f32_16x16x32_bf16 v[244:247], v[184:187], v[20:23], v[244:247]
    buffer_load_dwordx4 v[56:59], v164, s[12:15], s45 offen sc1
    v_mfma_f32_16x16x32_bf16 v[228:231], v[188:191], v[16:19], v[228:231]
    v_mfma_f32_16x16x32_bf16 v[248:251], v[188:191], v[20:23], v[248:251]
    v_mfma_f32_16x16x32_bf16 v[232:235], v[192:195], v[16:19], v[232:235]
    buffer_load_dwordx4 v[60:63], v164, s[12:15], s45 offen offset:256 sc1
    s_add_u32 s45, s45, 131072
    v_mfma_f32_16x16x32_bf16 v[252:255], v[192:195], v[20:23], v[252:255]
    s_waitcnt vmcnt(8) lgkmcnt(0)
    v_mfma_f32_16x16x32_bf16 v[216:219], v[196:199], v[24:27], v[216:219]
    ds_read_b64_tr_b16 v[176:177], v100 offset:10240
    ds_read_b64_tr_b16 v[178:179], v101 offset:10240
    v_mfma_f32_16x16x32_bf16 v[236:239], v[196:199], v[28:31], v[236:239]
    ds_read_b64_tr_b16 v[180:181], v100 offset:10272
    ds_read_b64_tr_b16 v[182:183], v101 offset:10272
    v_mfma_f32_16x16x32_bf16 v[220:223], v[200:203], v[24:27], v[220:223]
    ds_read_b64_tr_b16 v[184:185], v100 offset:10304
    ds_read_b64_tr_b16 v[186:187], v101 offset:10304
    v_mfma_f32_16x16x32_bf16 v[240:243], v[200:203], v[28:31], v[240:243]
    ds_read_b64_tr_b16 v[188:189], v100 offset:10336
    ds_read_b64_tr_b16 v[190:191], v101 offset:10336
    v_mfma_f32_16x16x32_bf16 v[224:227], v[204:207], v[24:27], v[224:227]
    ds_read_b64_tr_b16 v[192:193], v100 offset:10368
    ds_read_b64_tr_b16 v[194:195], v101 offset:10368
    v_mfma_f32_16x16x32_bf16 v[244:247], v[204:207], v[28:31], v[244:247]
    buffer_load_dwordx4 v[64:67], v164, s[12:15], s45 offen sc1
    v_mfma_f32_16x16x32_bf16 v[228:231], v[208:211], v[24:27], v[228:231]
    v_mfma_f32_16x16x32_bf16 v[248:251], v[208:211], v[28:31], v[248:251]
    v_mfma_f32_16x16x32_bf16 v[232:235], v[212:215], v[24:27], v[232:235]
    buffer_load_dwordx4 v[68:71], v164, s[12:15], s45 offen offset:256 sc1
    s_add_u32 s45, s45, 131072
    v_mfma_f32_16x16x32_bf16 v[252:255], v[212:215], v[28:31], v[252:255]
    s_waitcnt vmcnt(8) lgkmcnt(0)
    v_mfma_f32_16x16x32_bf16 v[216:219], v[176:179], v[32:35], v[216:219]
    ds_read_b64_tr_b16 v[196:197], v100 offset:15360
    ds_read_b64_tr_b16 v[198:199], v101 offset:15360
    v_mfma_f32_16x16x32_bf16 v[236:239], v[176:179], v[36:39], v[236:239]
    ds_read_b64_tr_b16 v[200:201], v100 offset:15392
    ds_read_b64_tr_b16 v[202:203], v101 offset:15392
    v_mfma_f32_16x16x32_bf16 v[220:223], v[180:183], v[32:35], v[220:223]
    ds_read_b64_tr_b16 v[204:205], v100 offset:15424
    ds_read_b64_tr_b16 v[206:207], v101 offset:15424
    v_mfma_f32_16x16x32_bf16 v[240:243], v[180:183], v[36:39], v[240:243]
    ds_read_b64_tr_b16 v[208:209], v100 offset:15456
    ds_read_b64_tr_b16 v[210:211], v101 offset:15456
    v_mfma_f32_16x16x32_bf16 v[224:227], v[184:187], v[32:35], v[224:227]
    ds_read_b64_tr_b16 v[212:213], v100 offset:15488
    ds_read_b64_tr_b16 v[214:215], v101 offset:15488
    v_mfma_f32_16x16x32_bf16 v[244:247], v[184:187], v[36:39], v[244:247]
    buffer_load_dwordx4 v[72:75], v164, s[12:15], s45 offen sc1
    v_mfma_f32_16x16x32_bf16 v[228:231], v[188:191], v[32:35], v[228:231]
    v_mfma_f32_16x16x32_bf16 v[248:251], v[188:191], v[36:39], v[248:251]
    v_mfma_f32_16x16x32_bf16 v[232:235], v[192:195], v[32:35], v[232:235]
    buffer_load_dwordx4 v[76:79], v164, s[12:15], s45 offen offset:256 sc1
    s_add_u32 s45, s45, 131072
    v_mfma_f32_16x16x32_bf16 v[252:255], v[192:195], v[36:39], v[252:255]
    s_waitcnt vmcnt(8) lgkmcnt(0)
    v_mfma_f32_16x16x32_bf16 v[216:219], v[196:199], v[40:43], v[216:219]
    ds_read_b64_tr_b16 v[176:177], v100 offset:20480
    ds_read_b64_tr_b16 v[178:179], v101 offset:20480
    v_mfma_f32_16x16x32_bf16 v[236:239], v[196:199], v[44:47], v[236:239]
    ds_read_b64_tr_b16 v[180:181], v100 offset:20512
    ds_read_b64_tr_b16 v[182:183], v101 offset:20512
    v_mfma_f32_16x16x32_bf16 v[220:223], v[200:203], v[40:43], v[220:223]
    ds_read_b64_tr_b16 v[184:185], v100 offset:20544
    ds_read_b64_tr_b16 v[186:187], v101 offset:20544
    v_mfma_f32_16x16x32_bf16 v[240:243], v[200:203], v[44:47], v[240:243]
    ds_read_b64_tr_b16 v[188:189], v100 offset:20576
    ds_read_b64_tr_b16 v[190:191], v101 offset:20576
    v_mfma_f32_16x16x32_bf16 v[224:227], v[204:207], v[40:43], v[224:227]
    ds_read_b64_tr_b16 v[192:193], v100 offset:20608
    ds_read_b64_tr_b16 v[194:195], v101 offset:20608
    v_mfma_f32_16x16x32_bf16 v[244:247], v[204:207], v[44:47], v[244:247]
    buffer_load_dwordx4 v[80:83], v164, s[12:15], s45 offen sc1
    v_mfma_f32_16x16x32_bf16 v[228:231], v[208:211], v[40:43], v[228:231]
    v_mfma_f32_16x16x32_bf16 v[248:251], v[208:211], v[44:47], v[248:251]
    v_mfma_f32_16x16x32_bf16 v[232:235], v[212:215], v[40:43], v[232:235]
    buffer_load_dwordx4 v[84:87], v164, s[12:15], s45 offen offset:256 sc1
    s_add_u32 s45, s45, 131072
    v_mfma_f32_16x16x32_bf16 v[252:255], v[212:215], v[44:47], v[252:255]
    s_waitcnt vmcnt(8) lgkmcnt(0)
    v_mfma_f32_16x16x32_bf16 v[216:219], v[176:179], v[48:51], v[216:219]
    ds_read_b64_tr_b16 v[196:197], v102 offset:0
    ds_read_b64_tr_b16 v[198:199], v103 offset:0
    v_mfma_f32_16x16x32_bf16 v[236:239], v[176:179], v[52:55], v[236:239]
    ds_read_b64_tr_b16 v[200:201], v102 offset:32
    ds_read_b64_tr_b16 v[202:203], v103 offset:32
    v_mfma_f32_16x16x32_bf16 v[220:223], v[180:183], v[48:51], v[220:223]
    ds_read_b64_tr_b16 v[204:205], v102 offset:64
    ds_read_b64_tr_b16 v[206:207], v103 offset:64
    v_mfma_f32_16x16x32_bf16 v[240:243], v[180:183], v[52:55], v[240:243]
    ds_read_b64_tr_b16 v[208:209], v102 offset:96
    ds_read_b64_tr_b16 v[210:211], v103 offset:96
    v_mfma_f32_16x16x32_bf16 v[224:227], v[184:187], v[48:51], v[224:227]
    ds_read_b64_tr_b16 v[212:213], v102 offset:128
    ds_read_b64_tr_b16 v[214:215], v103 offset:128
    v_mfma_f32_16x16x32_bf16 v[244:247], v[184:187], v[52:55], v[244:247]
    buffer_load_dwordx4 v[88:91], v164, s[12:15], s45 offen sc1
    v_mfma_f32_16x16x32_bf16 v[228:231], v[188:191], v[48:51], v[228:231]
    v_mfma_f32_16x16x32_bf16 v[248:251], v[188:191], v[52:55], v[248:251]
    v_mfma_f32_16x16x32_bf16 v[232:235], v[192:195], v[48:51], v[232:235]
    buffer_load_dwordx4 v[92:95], v164, s[12:15], s45 offen offset:256 sc1
    s_add_u32 s45, s45, 131072
    v_mfma_f32_16x16x32_bf16 v[252:255], v[192:195], v[52:55], v[252:255]
    s_cmp_lg_u32 s30, 0
    s_cbranch_scc1 p3_b1
p3_w1:
    ds_read_b32 v96, v174 offset:20
    s_waitcnt lgkmcnt(0)
    v_readfirstlane_b32 s30, v96
    s_sleep 1
    s_cmp_eq_u32 s30, 0
    s_cbranch_scc1 p3_w1
    s_mul_i32 s31, s30, 655360
    s_add_u32 s45, s60, s31
    s_cmp_eq_u32 s30, 0
    s_cselect_b32 s45, 0x40000000, s45
    s_cmp_eq_u32 s30, 2
    s_cselect_b32 s31, 25600, 0
    s_cmp_eq_u32 s30, 3
    s_cselect_b32 s31, 125952, s31
    s_cmp_eq_u32 s30, 4
    s_cselect_b32 s31, 100352, s31
    v_add_u32 v102, s31, v165
    v_add_u32 v103, s31, v166
    s_waitcnt vmcnt(0)
    buffer_load_dwordx4 v[56:59], v164, s[12:15], s45 offen sc1
    buffer_load_dwordx4 v[60:63], v164, s[12:15], s45 offen offset:256 sc1
    s_add_u32 s45, s45, 131072
    buffer_load_dwordx4 v[64:67], v164, s[12:15], s45 offen sc1
    buffer_load_dwordx4 v[68:71], v164, s[12:15], s45 offen offset:256 sc1
    s_add_u32 s45, s45, 131072
    buffer_load_dwordx4 v[72:75], v164, s[12:15], s45 offen sc1
    buffer_load_dwordx4 v[76:79], v164, s[12:15], s45 offen offset:256 sc1
    s_add_u32 s45, s45, 131072
    buffer_load_dwordx4 v[80:83], v164, s[12:15], s45 offen sc1
    buffer_load_dwordx4 v[84:87], v164, s[12:15], s45 offen offset:256 sc1
    s_add_u32 s45, s45, 131072
    buffer_load_dwordx4 v[88:91], v164, s[12:15], s45 offen sc1
    buffer_load_dwordx4 v[92:95], v164, s[12:15], s45 offen offset:256 sc1
    s_add_u32 s45, s45, 131072
    ds_read_b64_tr_b16 v[196:197], v102 offset:0
    ds_read_b64_tr_b16 v[198:199], v103 offset:0
    ds_read_b64_tr_b16 v[200:201], v102 offset:32
    ds_read_b64_tr_b16 v[202:203], v103 offset:32
    ds_read_b64_tr_b16 v[204:205], v102 offset:64
    ds_read_b64_tr_b16 v[206:207], v103 offset:64
    ds_read_b64_tr_b16 v[208:209], v102 offset:96
    ds_read_b64_tr_b16 v[210:211], v103 offset:96
    ds_read_b64_tr_b16 v[212:213], v102 offset:128
    ds_read_b64_tr_b16 v[214:215], v103 offset:128
p3_b1:
    ds_read_b32 v96, v174 offset:24
    s_waitcnt vmcnt(8) lgkmcnt(0)
    v_readfirstlane_b32 s30, v96
    s_nop 0
    v_mfma_f32_16x16x32_bf16 v[216:219], v[196:199], v[56:59], v[216:219]
    ds_read_b64_tr_b16 v[176:177], v102 offset:5120
    ds_read_b64_tr_b16 v[178:179], v103 offset:5120
    v_mfma_f32_16x16x32_bf16 v[236:239], v[196:199], v[60:63], v[236:239]
    ds_read_b64_tr_b16 v[180:181], v102 offset:5152
    ds_read_b64_tr_b16 v[182:183], v103 offset:5152
    v_mfma_f32_16x16x32_bf16 v[220:223], v[200:203], v[56:59], v[220:223]
    ds_read_b64_tr_b16 v[184:185], v102 offset:5184
    ds_read_b64_tr_b16 v[186:187], v103 offset:5184
    v_mfma_f32_16x16x32_bf16 v[240:243], v[200:203], v[60:63], v[240:243]
    ds_read_b64_tr_b16 v[188:189], v102 offset:5216
    ds_read_b64_tr_b16 v[190:191], v103 offset:5216
    v_mfma_f32_16x16x32_bf16 v[224:227], v[204:207], v[56:59], v[224:227]
    ds_read_b64_tr_b16 v[192:193], v102 offset:5248
    ds_read_b64_tr_b16 v[194:195], v103 offset:5248
    s_mul_i32 s31, s30, 655360
    s_add_u32 s45, s60, s31
    s_cmp_eq_u32 s30, 0
    s_cselect_b32 s45, 0x40000000, s45
    s_cmp_eq_u32 s30, 2
    s_cselect_b32 s31, 25600, 0
    s_cmp_eq_u32 s30, 3
    s_cselect_b32 s31, 125952, s31
    s_cmp_eq_u32 s30, 4
    s_cselect_b32 s31, 100352, s31
    v_add_u32 v100, s31, v165
    v_add_u32 v101, s31, v166
    v_mfma_f32_16x16x32_bf16 v[244:247], v[204:207], v[60:63], v[244:247]
    buffer_load_dwordx4 v[16:19], v164, s[12:15], s45 offen sc1
    v_mfma_f32_16x16x32_bf16 v[228:231], v[208:211], v[56:59], v[228:231]
    v_mfma_f32_16x16x32_bf16 v[248:251], v[208:211], v[60:63], v[248:251]
    v_mfma_f32_16x16x32_bf16 v[232:235], v[212:215], v[56:59], v[232:235]
    buffer_load_dwordx4 v[20:23], v164, s[12:15], s45 offen offset:256 sc1
    s_add_u32 s45, s45, 131072
    v_mfma_f32_16x16x32_bf16 v[252:255], v[212:215], v[60:63], v[252:255]
    s_waitcnt vmcnt(8) lgkmcnt(0)
    v_mfma_f32_16x16x32_bf16 v[216:219], v[176:179], v[64:67], v[216:219]
    ds_read_b64_tr_b16 v[196:197], v102 offset:10240
    ds_read_b64_tr_b16 v[198:199], v103 offset:10240
    v_mfma_f32_16x16x32_bf16 v[236:239], v[176:179], v[68:71], v[236:239]
    ds_read_b64_tr_b16 v[200:201], v102 offset:10272
    ds_read_b64_tr_b16 v[202:203], v103 offset:10272
    v_mfma_f32_16x16x32_bf16 v[220:223], v[180:183], v[64:67], v[220:223]
    ds_read_b64_tr_b16 v[204:205], v102 offset:10304
    ds_read_b64_tr_b16 v[206:207], v103 offset:10304
    v_mfma_f32_16x16x32_bf16 v[240:243], v[180:183], v[68:71], v[240:243]
    ds_read_b64_tr_b16 v[208:209], v102 offset:10336
    ds_read_b64_tr_b16 v[210:211], v103 offset:10336
    v_mfma_f32_16x16x32_bf16 v[224:227], v[184:187], v[64:67], v[224:227]
    ds_read_b64_tr_b16 v[212:213], v102 offset:10368
    ds_read_b64_tr_b16 v[214:215], v103 offset:10368
    v_mfma_f32_16x16x32_bf16 v[244:247], v[184:187], v[68:71], v[244:247]
    buffer_load_dwordx4 v[24:27], v164, s[12:15], s45 offen sc1
    v_mfma_f32_16x16x32_bf16 v[228:231], v[188:191], v[64:67], v[228:231]
    v_mfma_f32_16x16x32_bf16 v[248:251], v[188:191], v[68:71], v[248:251]
    v_mfma_f32_16x16x32_bf16 v[232:235], v[192:195], v[64:67], v[232:235]
    buffer_load_dwordx4 v[28:31], v164, s[12:15], s45 offen offset:256 sc1
    s_add_u32 s45, s45, 131072
    v_mfma_f32_16x16x32_bf16 v[252:255], v[192:195], v[68:71], v[252:255]
    s_waitcnt vmcnt(8) lgkmcnt(0)
    v_mfma_f32_16x16x32_bf16 v[216:219], v[196:199], v[72:75], v[216:219]
    ds_read_b64_tr_b16 v[176:177], v102 offset:15360
    ds_read_b64_tr_b16 v[178:179], v103 offset:15360
    v_mfma_f32_16x16x32_bf16 v[236:239], v[196:199], v[76:79], v[236:239]
    ds_read_b64_tr_b16 v[180:181], v102 offset:15392
    ds_read_b64_tr_b16 v[182:183], v103 offset:15392
    v_mfma_f32_16x16x32_bf16 v[220:223], v[200:203], v[72:75], v[220:223]
    ds_read_b64_tr_b16 v[184:185], v102 offset:15424
    ds_read_b64_tr_b16 v[186:187], v103 offset:15424
    v_mfma_f32_16x16x32_bf16 v[240:243], v[200:203], v[76:79], v[240:243]
    ds_read_b64_tr_b16 v[188:189], v102 offset:15456
    ds_read_b64_tr_b16 v[190:191], v103 offset:15456
    v_mfma_f32_16x16x32_bf16 v[224:227], v[204:207], v[72:75], v[224:227]
    ds_read_b64_tr_b16 v[192:193], v102 offset:15488
    ds_read_b64_tr_b16 v[194:195], v103 offset:15488
    v_mfma_f32_16x16x32_bf16 v[244:247], v[204:207], v[76:79], v[244:247]
    buffer_load_dwordx4 v[32:35], v164, s[12:15], s45 offen sc1
    v_mfma_f32_16x16x32_bf16 v[228:231], v[208:211], v[72:75], v[228:231]
    v_mfma_f32_16x16x32_bf16 v[248:251], v[208:211], v[76:79], v[248:251]
    v_mfma_f32_16x16x32_bf16 v[232:235], v[212:215], v[72:75], v[232:235]
    buffer_load_dwordx4 v[36:39], v164, s[12:15], s45 offen offset:256 sc1
    s_add_u32 s45, s45, 131072
    v_mfma_f32_16x16x32_bf16 v[252:255], v[212:215], v[76:79], v[252:255]
    s_waitcnt vmcnt(8) lgkmcnt(0)
    v_mfma_f32_16x16x32_bf16 v[216:219], v[176:179], v[80:83], v[216:219]
    ds_read_b64_tr_b16 v[196:197], v102 offset:20480
    ds_read_b64_tr_b16 v[198:199], v103 offset:20480
    v_mfma_f32_16x16x32_bf16 v[236:239], v[176:179], v[84:87], v[236:239]
    ds_read_b64_tr_b16 v[200:201], v102 offset:20512
    ds_read_b64_tr_b16 v[202:203], v103 offset:20512
    v_mfma_f32_16x16x32_bf16 v[220:223], v[180:183], v[80:83], v[220:223]
    ds_read_b64_tr_b16 v[204:205], v102 offset:20544
    ds_read_b64_tr_b16 v[206:207], v103 offset:20544
    v_mfma_f32_16x16x32_bf16 v[240:243], v[180:183], v[84:87], v[240:243]
    ds_read_b64_tr_b16 v[208:209], v102 offset:20576
    ds_read_b64_tr_b16 v[210:211], v103 offset:20576
    v_mfma_f32_16x16x32_bf16 v[224:227], v[184:187], v[80:83], v[224:227]
    ds_read_b64_tr_b16 v[212:213], v102 offset:20608
    ds_read_b64_tr_b16 v[214:215], v103 offset:20608
    v_mfma_f32_16x16x32_bf16 v[244:247], v[184:187], v[84:87], v[244:247]
    buffer_load_dwordx4 v[40:43], v164, s[12:15], s45 offen sc1
    v_mfma_f32_16x16x32_bf16 v[228:231], v[188:191], v[80:83], v[228:231]
    v_mfma_f32_16x16x32_bf16 v[248:251], v[188:191], v[84:87], v[248:251]
    v_mfma_f32_16x16x32_bf16 v[232:235], v[192:195], v[80:83], v[232:235]
    buffer_load_dwordx4 v[44:47], v164, s[12:15], s45 offen offset:256 sc1
    s_add_u32 s45, s45, 131072
    v_mfma_f32_16x16x32_bf16 v[252:255], v[192:195], v[84:87], v[252:255]
    s_waitcnt vmcnt(8) lgkmcnt(0)
    v_mfma_f32_16x16x32_bf16 v[216:219], v[196:199], v[88:91], v[216:219]
    ds_read_b64_tr_b16 v[176:177], v100 offset:0
    ds_read_b64_tr_b16 v[178:179], v101 offset:0
    v_mfma_f32_16x16x32_bf16 v[236:239], v[196:199], v[92:95], v[236:239]
    ds_read_b64_tr_b16 v[180:181], v100 offset:32
    ds_read_b64_tr_b16 v[182:183], v101 offset:32
    v_mfma_f32_16x16x32_bf16 v[220:223], v[200:203], v[88:91], v[220:223]
    ds_read_b64_tr_b16 v[184:185], v100 offset:64
    ds_read_b64_tr_b16 v[186:187], v101 offset:64
    v_mfma_f32_16x16x32_bf16 v[240:243], v[200:203], v[92:95], v[240:243]
    ds_read_b64_tr_b16 v[188:189], v100 offset:96
    ds_read_b64_tr_b16 v[190:191], v101 offset:96
    v_mfma_f32_16x16x32_bf16 v[224:227], v[204:207], v[88:91], v[224:227]
    ds_read_b64_tr_b16 v[192:193], v100 offset:128
    ds_read_b64_tr_b16 v[194:195], v101 offset:128
    v_mfma_f32_16x16x32_bf16 v[244:247], v[204:207], v[92:95], v[244:247]
    buffer_load_dwordx4 v[48:51], v164, s[12:15], s45 offen sc1
    v_mfma_f32_16x16x32_bf16 v[228:231], v[208:211], v[88:91], v[228:231]
    v_mfma_f32_16x16x32_bf16 v[248:251], v[208:211], v[92:95], v[248:251]
    v_mfma_f32_16x16x32_bf16 v[232:235], v[212:215], v[88:91], v[232:235]
    buffer_load_dwordx4 v[52:55], v164, s[12:15], s45 offen offset:256 sc1
    s_add_u32 s45, s45, 131072
    v_mfma_f32_16x16x32_bf16 v[252:255], v[212:215], v[92:95], v[252:255]
    s_cmp_lg_u32 s30, 0
    s_cbranch_scc1 p3_b2
p3_w2:
    ds_read_b32 v96, v174 offset:24
    s_waitcnt lgkmcnt(0)
    v_readfirstlane_b32 s30, v96
    s_sleep 1
    s_cmp_eq_u32 s30, 0
    s_cbranch_scc1 p3_w2
    s_mul_i32 s31, s30, 655360
    s_add_u32 s45, s60, s31
    s_cmp_eq_u32 s30, 0
    s_cselect_b32 s45, 0x40000000, s45
    s_cmp_eq_u32 s30, 2
    s_cselect_b32 s31, 25600, 0
    s_cmp_eq_u32 s30, 3
    s_cselect_b32 s31, 125952, s31
    s_cmp_eq_u32 s30, 4
    s_cselect_b32 s31, 100352, s31
    v_add_u32 v100, s31, v165
    v_add_u32 v101, s31, v166
    s_waitcnt vmcnt(0)
    buffer_load_dwordx4 v[16:19], v164, s[12:15], s45 offen sc1
    buffer_load_dwordx4 v[20:23], v164, s[12:15], s45 offen offset:256 sc1
    s_add_u32 s45, s45, 131072
    buffer_load_dwordx4 v[24:27], v164, s[12:15], s45 offen sc1
    buffer_load_dwordx4 v[28:31], v164, s[12:15], s45 offen offset:256 sc1
    s_add_u32 s45, s45, 131072
    buffer_load_dwordx4 v[32:35], v164, s[12:15], s45 offen sc1
    buffer_load_dwordx4 v[36:39], v164, s[12:15], s45 offen offset:256 sc1
    s_add_u32 s45, s45, 131072
    buffer_load_dwordx4 v[40:43], v164, s[12:15], s45 offen sc1
    buffer_load_dwordx4 v[44:47], v164, s[12:15], s45 offen offset:256 sc1
    s_add_u32 s45, s45, 131072
    buffer_load_dwordx4 v[48:51], v164, s[12:15], s45 offen sc1
    buffer_load_dwordx4 v[52:55], v164, s[12:15], s45 offen offset:256 sc1
    s_add_u32 s45, s45, 131072
    ds_read_b64_tr_b16 v[176:177], v100 offset:0
    ds_read_b64_tr_b16 v[178:179], v101 offset:0
    ds_read_b64_tr_b16 v[180:181], v100 offset:32
    ds_read_b64_tr_b16 v[182:183], v101 offset:32
    ds_read_b64_tr_b16 v[184:185], v100 offset:64
    ds_read_b64_tr_b16 v[186:187], v101 offset:64
    ds_read_b64_tr_b16 v[188:189], v100 offset:96
    ds_read_b64_tr_b16 v[190:191], v101 offset:96
    ds_read_b64_tr_b16 v[192:193], v100 offset:128
    ds_read_b64_tr_b16 v[194:195], v101 offset:128
p3_b2:
    ds_read_b32 v96, v174 offset:28
    s_waitcnt vmcnt(8) lgkmcnt(0)
    v_readfirstlane_b32 s30, v96
    s_nop 0
    v_mfma_f32_16x16x32_bf16 v[216:219], v[176:179], v[16:19], v[216:219]
    ds_read_b64_tr_b16 v[196:197], v100 offset:5120
    ds_read_b64_tr_b16 v[198:199], v101 offset:5120
    v_mfma_f32_16x16x32_bf16 v[236:239], v[176:179], v[20:23], v[236:239]
    ds_read_b64_tr_b16 v[200:201], v100 offset:5152
    ds_read_b64_tr_b16 v[202:203], v101 offset:5152
    v_mfma_f32_16x16x32_bf16 v[220:223], v[180:183], v[16:19], v[220:223]
    ds_read_b64_tr_b16 v[204:205], v100 offset:5184
    ds_read_b64_tr_b16 v[206:207], v101 offset:5184
    v_mfma_f32_16x16x32_bf16 v[240:243], v[180:183], v[20:23], v[240:243]
    ds_read_b64_tr_b16 v[208:209], v100 offset:5216
    ds_read_b64_tr_b16 v[210:211], v101 offset:5216
    v_mfma_f32_16x16x32_bf16 v[224:227], v[184:187], v[16:19], v[224:227]
    ds_read_b64_tr_b16 v[212:213], v100 offset:5248
    ds_read_b64_tr_b16 v[214:215], v101 offset:5248
    s_mul_i32 s31, s30, 655360
    s_add_u32 s45, s60, s31
    s_cmp_eq_u32 s30, 0
    s_cselect_b32 s45, 0x40000000, s45
    s_cmp_eq_u32 s30, 2
    s_cselect_b32 s31, 25600, 0
    s_cmp_eq_u32 s30, 3
    s_cselect_b32 s31, 125952, s31
    s_cmp_eq_u32 s30, 4
    s_cselect_b32 s31, 100352, s31
    v_add_u32 v102, s31, v165
    v_add_u32 v103, s31, v166
    v_mfma_f32_16x16x32_bf16 v[244:247], v[184:187], v[20:23], v[244:247]
    buffer_load_dwordx4 v[56:59], v164, s[12:15], s45 offen sc1
    v_mfma_f32_16x16x32_bf16 v[228:231], v[188:191], v[16:19], v[228:231]
    v_mfma_f32_16x16x32_bf16 v[248:251], v[188:191], v[20:23], v[248:251]
    v_mfma_f32_16x16x32_bf16 v[232:235], v[192:195], v[16:19], v[232:235]
    buffer_load_dwordx4 v[60:63], v164, s[12:15], s45 offen offset:256 sc1
    s_add_u32 s45, s45, 131072
    v_mfma_f32_16x16x32_bf16 v[252:255], v[192:195], v[20:23], v[252:255]
    s_waitcnt vmcnt(8) lgkmcnt(0)
    v_mfma_f32_16x16x32_bf16 v[216:219], v[196:199], v[24:27], v[216:219]
    ds_read_b64_tr_b16 v[176:177], v100 offset:10240
    ds_read_b64_tr_b16 v[178:179], v101 offset:10240
    v_mfma_f32_16x16x32_bf16 v[236:239], v[196:199], v[28:31], v[236:239]
    ds_read_b64_tr_b16 v[180:181], v100 offset:10272
    ds_read_b64_tr_b16 v[182:183], v101 offset:10272
    v_mfma_f32_16x16x32_bf16 v[220:223], v[200:203], v[24:27], v[220:223]
    ds_read_b64_tr_b16 v[184:185], v100 offset:10304
    ds_read_b64_tr_b16 v[186:187], v101 offset:10304
    v_mfma_f32_16x16x32_bf16 v[240:243], v[200:203], v[28:31], v[240:243]
    ds_read_b64_tr_b16 v[188:189], v100 offset:10336
    ds_read_b64_tr_b16 v[190:191], v101 offset:10336
    v_mfma_f32_16x16x32_bf16 v[224:227], v[204:207], v[24:27], v[224:227]
    ds_read_b64_tr_b16 v[192:193], v100 offset:10368
    ds_read_b64_tr_b16 v[194:195], v101 offset:10368
    v_mfma_f32_16x16x32_bf16 v[244:247], v[204:207], v[28:31], v[244:247]
    buffer_load_dwordx4 v[64:67], v164, s[12:15], s45 offen sc1
    v_mfma_f32_16x16x32_bf16 v[228:231], v[208:211], v[24:27], v[228:231]
    v_mfma_f32_16x16x32_bf16 v[248:251], v[208:211], v[28:31], v[248:251]
    v_mfma_f32_16x16x32_bf16 v[232:235], v[212:215], v[24:27], v[232:235]
    buffer_load_dwordx4 v[68:71], v164, s[12:15], s45 offen offset:256 sc1
    s_add_u32 s45, s45, 131072
    v_mfma_f32_16x16x32_bf16 v[252:255], v[212:215], v[28:31], v[252:255]
    s_waitcnt vmcnt(8) lgkmcnt(0)
    v_mfma_f32_16x16x32_bf16 v[216:219], v[176:179], v[32:35], v[216:219]
    ds_read_b64_tr_b16 v[196:197], v100 offset:15360
    ds_read_b64_tr_b16 v[198:199], v101 offset:15360
    v_mfma_f32_16x16x32_bf16 v[236:239], v[176:179], v[36:39], v[236:239]
    ds_read_b64_tr_b16 v[200:201], v100 offset:15392
    ds_read_b64_tr_b16 v[202:203], v101 offset:15392
    v_mfma_f32_16x16x32_bf16 v[220:223], v[180:183], v[32:35], v[220:223]
    ds_read_b64_tr_b16 v[204:205], v100 offset:15424
    ds_read_b64_tr_b16 v[206:207], v101 offset:15424
    v_mfma_f32_16x16x32_bf16 v[240:243], v[180:183], v[36:39], v[240:243]
    ds_read_b64_tr_b16 v[208:209], v100 offset:15456
    ds_read_b64_tr_b16 v[210:211], v101 offset:15456
    v_mfma_f32_16x16x32_bf16 v[224:227], v[184:187], v[32:35], v[224:227]
    ds_read_b64_tr_b16 v[212:213], v100 offset:15488
    ds_read_b64_tr_b16 v[214:215], v101 offset:15488
    v_mfma_f32_16x16x32_bf16 v[244:247], v[184:187], v[36:39], v[244:247]
    buffer_load_dwordx4 v[72:75], v164, s[12:15], s45 offen sc1
    v_mfma_f32_16x16x32_bf16 v[228:231], v[188:191], v[32:35], v[228:231]
    v_mfma_f32_16x16x32_bf16 v[248:251], v[188:191], v[36:39], v[248:251]
    v_mfma_f32_16x16x32_bf16 v[232:235], v[192:195], v[32:35], v[232:235]
    buffer_load_dwordx4 v[76:79], v164, s[12:15], s45 offen offset:256 sc1
    s_add_u32 s45, s45, 131072
    v_mfma_f32_16x16x32_bf16 v[252:255], v[192:195], v[36:39], v[252:255]
    s_waitcnt vmcnt(8) lgkmcnt(0)
    v_mfma_f32_16x16x32_bf16 v[216:219], v[196:199], v[40:43], v[216:219]
    ds_read_b64_tr_b16 v[176:177], v100 offset:20480
    ds_read_b64_tr_b16 v[178:179], v101 offset:20480
    v_mfma_f32_16x16x32_bf16 v[236:239], v[196:199], v[44:47], v[236:239]
    ds_read_b64_tr_b16 v[180:181], v100 offset:20512
    ds_read_b64_tr_b16 v[182:183], v101 offset:20512
    v_mfma_f32_16x16x32_bf16 v[220:223], v[200:203], v[40:43], v[220:223]
    ds_read_b64_tr_b16 v[184:185], v100 offset:20544
    ds_read_b64_tr_b16 v[186:187], v101 offset:20544
    v_mfma_f32_16x16x32_bf16 v[240:243], v[200:203], v[44:47], v[240:243]
    ds_read_b64_tr_b16 v[188:189], v100 offset:20576
    ds_read_b64_tr_b16 v[190:191], v101 offset:20576
    v_mfma_f32_16x16x32_bf16 v[224:227], v[204:207], v[40:43], v[224:227]
    ds_read_b64_tr_b16 v[192:193], v100 offset:20608
    ds_read_b64_tr_b16 v[194:195], v101 offset:20608
    v_mfma_f32_16x16x32_bf16 v[244:247], v[204:207], v[44:47], v[244:247]
    buffer_load_dwordx4 v[80:83], v164, s[12:15], s45 offen sc1
    v_mfma_f32_16x16x32_bf16 v[228:231], v[208:211], v[40:43], v[228:231]
    v_mfma_f32_16x16x32_bf16 v[248:251], v[208:211], v[44:47], v[248:251]
    v_mfma_f32_16x16x32_bf16 v[232:235], v[212:215], v[40:43], v[232:235]
    buffer_load_dwordx4 v[84:87], v164, s[12:15], s45 offen offset:256 sc1
    s_add_u32 s45, s45, 131072
    v_mfma_f32_16x16x32_bf16 v[252:255], v[212:215], v[44:47], v[252:255]
    s_waitcnt vmcnt(8) lgkmcnt(0)
    v_mfma_f32_16x16x32_bf16 v[216:219], v[176:179], v[48:51], v[216:219]
    ds_read_b64_tr_b16 v[196:197], v102 offset:0
    ds_read_b64_tr_b16 v[198:199], v103 offset:0
    v_mfma_f32_16x16x32_bf16 v[236:239], v[176:179], v[52:55], v[236:239]
    ds_read_b64_tr_b16 v[200:201], v102 offset:32
    ds_read_b64_tr_b16 v[202:203], v103 offset:32
    v_mfma_f32_16x16x32_bf16 v[220:223], v[180:183], v[48:51], v[220:223]
    ds_read_b64_tr_b16 v[204:205], v102 offset:64
    ds_read_b64_tr_b16 v[206:207], v103 offset:64
    v_mfma_f32_16x16x32_bf16 v[240:243], v[180:183], v[52:55], v[240:243]
    ds_read_b64_tr_b16 v[208:209], v102 offset:96
    ds_read_b64_tr_b16 v[210:211], v103 offset:96
    v_mfma_f32_16x16x32_bf16 v[224:227], v[184:187], v[48:51], v[224:227]
    ds_read_b64_tr_b16 v[212:213], v102 offset:128
    ds_read_b64_tr_b16 v[214:215], v103 offset:128
    v_mfma_f32_16x16x32_bf16 v[244:247], v[184:187], v[52:55], v[244:247]
    buffer_load_dwordx4 v[88:91], v164, s[12:15], s45 offen sc1
    v_mfma_f32_16x16x32_bf16 v[228:231], v[188:191], v[48:51], v[228:231]
    v_mfma_f32_16x16x32_bf16 v[248:251], v[188:191], v[52:55], v[248:251]
    v_mfma_f32_16x16x32_bf16 v[232:235], v[192:195], v[48:51], v[232:235]
    buffer_load_dwordx4 v[92:95], v164, s[12:15], s45 offen offset:256 sc1
    s_add_u32 s45, s45, 131072
    v_mfma_f32_16x16x32_bf16 v[252:255], v[192:195], v[52:55], v[252:255]
    s_cmp_lg_u32 s30, 0
    s_cbranch_scc1 p3_b3
p3_w3:
    ds_read_b32 v96, v174 offset:28
    s_waitcnt lgkmcnt(0)
    v_readfirstlane_b32 s30, v96
    s_sleep 1
    s_cmp_eq_u32 s30, 0
    s_cbranch_scc1 p3_w3
    s_mul_i32 s31, s30, 655360
    s_add_u32 s45, s60, s31
    s_cmp_eq_u32 s30, 0
    s_cselect_b32 s45, 0x40000000, s45
    s_cmp_eq_u32 s30, 2
    s_cselect_b32 s31, 25600, 0
    s_cmp_eq_u32 s30, 3
    s_cselect_b32 s31, 125952, s31
    s_cmp_eq_u32 s30, 4
    s_cselect_b32 s31, 100352, s31
    v_add_u32 v102, s31, v165
    v_add_u32 v103, s31, v166
    s_waitcnt vmcnt(0)
    buffer_load_dwordx4 v[56:59], v164, s[12:15], s45 offen sc1
    buffer_load_dwordx4 v[60:63], v164, s[12:15], s45 offen offset:256 sc1
    s_add_u32 s45, s45, 131072
    buffer_load_dwordx4 v[64:67], v164, s[12:15], s45 offen sc1
    buffer_load_dwordx4 v[68:71], v164, s[12:15], s45 offen offset:256 sc1
    s_add_u32 s45, s45, 131072
    buffer_load_dwordx4 v[72:75], v164, s[12:15], s45 offen sc1
    buffer_load_dwordx4 v[76:79], v164, s[12:15], s45 offen offset:256 sc1
    s_add_u32 s45, s45, 131072
    buffer_load_dwordx4 v[80:83], v164, s[12:15], s45 offen sc1
    buffer_load_dwordx4 v[84:87], v164, s[12:15], s45 offen offset:256 sc1
    s_add_u32 s45, s45, 131072
    buffer_load_dwordx4 v[88:91], v164, s[12:15], s45 offen sc1
    buffer_load_dwordx4 v[92:95], v164, s[12:15], s45 offen offset:256 sc1
    s_add_u32 s45, s45, 131072
    ds_read_b64_tr_b16 v[196:197], v102 offset:0
    ds_read_b64_tr_b16 v[198:199], v103 offset:0
    ds_read_b64_tr_b16 v[200:201], v102 offset:32
    ds_read_b64_tr_b16 v[202:203], v103 offset:32
    ds_read_b64_tr_b16 v[204:205], v102 offset:64
    ds_read_b64_tr_b16 v[206:207], v103 offset:64
    ds_read_b64_tr_b16 v[208:209], v102 offset:96
    ds_read_b64_tr_b16 v[210:211], v103 offset:96
    ds_read_b64_tr_b16 v[212:213], v102 offset:128
    ds_read_b64_tr_b16 v[214:215], v103 offset:128
p3_b3:
    s_waitcnt vmcnt(8) lgkmcnt(0)
    v_mfma_f32_16x16x32_bf16 v[216:219], v[196:199], v[56:59], v[216:219]
    ds_read_b64_tr_b16 v[176:177], v102 offset:5120
    ds_read_b64_tr_b16 v[178:179], v103 offset:5120
    v_mfma_f32_16x16x32_bf16 v[236:239], v[196:199], v[60:63], v[236:239]
    ds_read_b64_tr_b16 v[180:181], v102 offset:5152
    ds_read_b64_tr_b16 v[182:183], v103 offset:5152
    v_mfma_f32_16x16x32_bf16 v[220:223], v[200:203], v[56:59], v[220:223]
    ds_read_b64_tr_b16 v[184:185], v102 offset:5184
    ds_read_b64_tr_b16 v[186:187], v103 offset:5184
    v_mfma_f32_16x16x32_bf16 v[240:243], v[200:203], v[60:63], v[240:243]
    ds_read_b64_tr_b16 v[188:189], v102 offset:5216
    ds_read_b64_tr_b16 v[190:191], v103 offset:5216
    v_mfma_f32_16x16x32_bf16 v[224:227], v[204:207], v[56:59], v[224:227]
    ds_read_b64_tr_b16 v[192:193], v102 offset:5248
    ds_read_b64_tr_b16 v[194:195], v103 offset:5248
    v_mfma_f32_16x16x32_bf16 v[244:247], v[204:207], v[60:63], v[244:247]
    v_mfma_f32_16x16x32_bf16 v[228:231], v[208:211], v[56:59], v[228:231]
    v_mfma_f32_16x16x32_bf16 v[248:251], v[208:211], v[60:63], v[248:251]
    v_mfma_f32_16x16x32_bf16 v[232:235], v[212:215], v[56:59], v[232:235]
    v_mfma_f32_16x16x32_bf16 v[252:255], v[212:215], v[60:63], v[252:255]
    s_waitcnt vmcnt(6) lgkmcnt(0)
    v_mfma_f32_16x16x32_bf16 v[216:219], v[176:179], v[64:67], v[216:219]
    ds_read_b64_tr_b16 v[196:197], v102 offset:10240
    ds_read_b64_tr_b16 v[198:199], v103 offset:10240
    v_mfma_f32_16x16x32_bf16 v[236:239], v[176:179], v[68:71], v[236:239]
    ds_read_b64_tr_b16 v[200:201], v102 offset:10272
    ds_read_b64_tr_b16 v[202:203], v103 offset:10272
    v_mfma_f32_16x16x32_bf16 v[220:223], v[180:183], v[64:67], v[220:223]
    ds_read_b64_tr_b16 v[204:205], v102 offset:10304
    ds_read_b64_tr_b16 v[206:207], v103 offset:10304
    v_mfma_f32_16x16x32_bf16 v[240:243], v[180:183], v[68:71], v[240:243]
    ds_read_b64_tr_b16 v[208:209], v102 offset:10336
    ds_read_b64_tr_b16 v[210:211], v103 offset:10336
    v_mfma_f32_16x16x32_bf16 v[224:227], v[184:187], v[64:67], v[224:227]
    ds_read_b64_tr_b16 v[212:213], v102 offset:10368
    ds_read_b64_tr_b16 v[214:215], v103 offset:10368
    v_mfma_f32_16x16x32_bf16 v[244:247], v[184:187], v[68:71], v[244:247]
    v_mfma_f32_16x16x32_bf16 v[228:231], v[188:191], v[64:67], v[228:231]
    v_mfma_f32_16x16x32_bf16 v[248:251], v[188:191], v[68:71], v[248:251]
    v_mfma_f32_16x16x32_bf16 v[232:235], v[192:195], v[64:67], v[232:235]
    v_mfma_f32_16x16x32_bf16 v[252:255], v[192:195], v[68:71], v[252:255]
    s_waitcnt vmcnt(4) lgkmcnt(0)
    v_mfma_f32_16x16x32_bf16 v[216:219], v[196:199], v[72:75], v[216:219]
    ds_read_b64_tr_b16 v[176:177], v102 offset:15360
    ds_read_b64_tr_b16 v[178:179], v103 offset:15360
    v_mfma_f32_16x16x32_bf16 v[236:239], v[196:199], v[76:79], v[236:239]
    ds_read_b64_tr_b16 v[180:181], v102 offset:15392
    ds_read_b64_tr_b16 v[182:183], v103 offset:15392
    v_mfma_f32_16x16x32_bf16 v[220:223], v[200:203], v[72:75], v[220:223]
    ds_read_b64_tr_b16 v[184:185], v102 offset:15424
    ds_read_b64_tr_b16 v[186:187], v103 offset:15424
    v_mfma_f32_16x16x32_bf16 v[240:243], v[200:203], v[76:79], v[240:243]
    ds_read_b64_tr_b16 v[188:189], v102 offset:15456
    ds_read_b64_tr_b16 v[190:191], v103 offset:15456
    v_mfma_f32_16x16x32_bf16 v[224:227], v[204:207], v[72:75], v[224:227]
    ds_read_b64_tr_b16 v[192:193], v102 offset:15488
    ds_read_b64_tr_b16 v[194:195], v103 offset:15488
    v_mfma_f32_16x16x32_bf16 v[244:247], v[204:207], v[76:79], v[244:247]
    v_mfma_f32_16x16x32_bf16 v[228:231], v[208:211], v[72:75], v[228:231]
    v_mfma_f32_16x16x32_bf16 v[248:251], v[208:211], v[76:79], v[248:251]
    v_mfma_f32_16x16x32_bf16 v[232:235], v[212:215], v[72:75], v[232:235]
    v_mfma_f32_16x16x32_bf16 v[252:255], v[212:215], v[76:79], v[252:255]
    s_waitcnt vmcnt(2) lgkmcnt(0)
    v_mfma_f32_16x16x32_bf16 v[216:219], v[176:179], v[80:83], v[216:219]
    ds_read_b64_tr_b16 v[196:197], v102 offset:20480
    ds_read_b64_tr_b16 v[198:199], v103 offset:20480
    v_mfma_f32_16x16x32_bf16 v[236:239], v[176:179], v[84:87], v[236:239]
    ds_read_b64_tr_b16 v[200:201], v102 offset:20512
    ds_read_b64_tr_b16 v[202:203], v103 offset:20512
    v_mfma_f32_16x16x32_bf16 v[220:223], v[180:183], v[80:83], v[220:223]
    ds_read_b64_tr_b16 v[204:205], v102 offset:20544
    ds_read_b64_tr_b16 v[206:207], v103 offset:20544
    v_mfma_f32_16x16x32_bf16 v[240:243], v[180:183], v[84:87], v[240:243]
    ds_read_b64_tr_b16 v[208:209], v102 offset:20576
    ds_read_b64_tr_b16 v[210:211], v103 offset:20576
    v_mfma_f32_16x16x32_bf16 v[224:227], v[184:187], v[80:83], v[224:227]
    ds_read_b64_tr_b16 v[212:213], v102 offset:20608
    ds_read_b64_tr_b16 v[214:215], v103 offset:20608
    v_mfma_f32_16x16x32_bf16 v[244:247], v[184:187], v[84:87], v[244:247]
    v_mfma_f32_16x16x32_bf16 v[228:231], v[188:191], v[80:83], v[228:231]
    v_mfma_f32_16x16x32_bf16 v[248:251], v[188:191], v[84:87], v[248:251]
    v_mfma_f32_16x16x32_bf16 v[232:235], v[192:195], v[80:83], v[232:235]
    v_mfma_f32_16x16x32_bf16 v[252:255], v[192:195], v[84:87], v[252:255]
    s_waitcnt vmcnt(0) lgkmcnt(0)
    v_mfma_f32_16x16x32_bf16 v[216:219], v[196:199], v[88:91], v[216:219]
    v_mfma_f32_16x16x32_bf16 v[236:239], v[196:199], v[92:95], v[236:239]
    v_mfma_f32_16x16x32_bf16 v[220:223], v[200:203], v[88:91], v[220:223]
    v_mfma_f32_16x16x32_bf16 v[240:243], v[200:203], v[92:95], v[240:243]
    v_mfma_f32_16x16x32_bf16 v[224:227], v[204:207], v[88:91], v[224:227]
    v_mfma_f32_16x16x32_bf16 v[244:247], v[204:207], v[92:95], v[244:247]
    v_mfma_f32_16x16x32_bf16 v[228:231], v[208:211], v[88:91], v[228:231]
    v_mfma_f32_16x16x32_bf16 v[248:251], v[208:211], v[92:95], v[248:251]
    v_mfma_f32_16x16x32_bf16 v[232:235], v[212:215], v[88:91], v[232:235]
    v_mfma_f32_16x16x32_bf16 v[252:255], v[212:215], v[92:95], v[252:255]
    s_nop 7
    v_cvt_pk_bf16_f32 v16, v216, v217
    v_cvt_pk_bf16_f32 v17, v218, v219
    ds_write_b64 v167, v[16:17] offset:0
    v_cvt_pk_bf16_f32 v18, v220, v221
    v_cvt_pk_bf16_f32 v19, v222, v223
    ds_write_b64 v167, v[18:19] offset:32
    v_cvt_pk_bf16_f32 v20, v224, v225
    v_cvt_pk_bf16_f32 v21, v226, v227
    ds_write_b64 v167, v[20:21] offset:64
    v_cvt_pk_bf16_f32 v22, v228, v229
    v_cvt_pk_bf16_f32 v23, v230, v231
    ds_write_b64 v167, v[22:23] offset:96
    v_cvt_pk_bf16_f32 v24, v232, v233
    v_cvt_pk_bf16_f32 v25, v234, v235
    ds_write_b64 v167, v[24:25] offset:128
    v_cvt_pk_bf16_f32 v26, v236, v237
    v_cvt_pk_bf16_f32 v27, v238, v239
    ds_write_b64 v167, v[26:27] offset:2560
    v_cvt_pk_bf16_f32 v28, v240, v241
    v_cvt_pk_bf16_f32 v29, v242, v243
    ds_write_b64 v167, v[28:29] offset:2592
    v_cvt_pk_bf16_f32 v30, v244, v245
    v_cvt_pk_bf16_f32 v31, v246, v247
    ds_write_b64 v167, v[30:31] offset:2624
    v_cvt_pk_bf16_f32 v32, v248, v249
    v_cvt_pk_bf16_f32 v33, v250, v251
    ds_write_b64 v167, v[32:33] offset:2656
    v_cvt_pk_bf16_f32 v34, v252, v253
    v_cvt_pk_bf16_f32 v35, v254, v255
    ds_write_b64 v167, v[34:35] offset:2688
    s_waitcnt lgkmcnt(0)
    ds_read_b128 v[48:51], v168 offset:0
    ds_read_b128 v[52:55], v168 offset:1024
    ds_read_b128 v[56:59], v168 offset:2048
    ds_read_b128 v[60:63], v168 offset:3072
    ds_read_b128 v[64:67], v168 offset:4096
    s_waitcnt lgkmcnt(4)
    buffer_store_dwordx4 v[48:51], v169, s[4:7], s61 offen
    s_waitcnt lgkmcnt(3)
    buffer_store_dwordx4 v[52:55], v170, s[4:7], s61 offen
    s_waitcnt lgkmcnt(2)
    buffer_store_dwordx4 v[56:59], v171, s[4:7], s61 offen
    s_waitcnt lgkmcnt(1)
    buffer_store_dwordx4 v[60:63], v172, s[4:7], s61 offen
    s_waitcnt lgkmcnt(0)
    buffer_store_dwordx4 v[64:67], v173, s[4:7], s61 offen
p3_ste:
k1_exit:
    s_endpgm
p2_havemax:
    s_waitcnt lgkmcnt(2)
    v_mfma_f32_32x32x16_bf16 v[68:83], v[32:35], v[16:19], v[100:115]
    v_mfma_f32_32x32x8_bf16 v[68:83], v[40:41], v[20:21], v[68:83]
    s_nop 7
    s_branch p2_enter
p2_fallback:
    s_mov_b32 s53, 1
    s_mov_b32 s67, -1
    s_mov_b32 s45, 0
    v_mov_b32 v2, 0xff800000
    v_mov_b32 v3, 0xff800000
    s_waitcnt vmcnt(0)
p2_mx_loop:
    s_barrier
    s_mov_b32 s46, 0
    v_mov_b32 v5, v8
    v_mov_b32 v6, v9
p2_mx_pair:
    ds_read_b128 v[32:35], v5
    ds_read_b128 v[36:39], v5 offset:512
    ds_read_b64 v[40:41], v6
    s_waitcnt lgkmcnt(0)
    v_mfma_f32_32x32x16_bf16 v[68:83], v[32:35], v[16:19], 0
    v_mfma_f32_32x32x8_bf16 v[68:83], v[40:41], v[20:21], v[68:83]
    v_mfma_f32_32x32x16_bf16 v[132:147], v[32:35], v[24:27], 0
    v_mfma_f32_32x32x8_bf16 v[132:147], v[40:41], v[28:29], v[132:147]
    v_mfma_f32_32x32x16_bf16 v[84:99], v[36:39], v[16:19], 0
    v_mfma_f32_32x32x8_bf16 v[84:99], v[40:41], v[22:23], v[84:99]
    v_mfma_f32_32x32x16_bf16 v[148:163], v[36:39], v[24:27], 0
    v_mfma_f32_32x32x8_bf16 v[148:163], v[40:41], v[30:31], v[148:163]
    v_add_u32 v5, 1024, v5
    v_add_u32 v6, 1024, v6
    s_nop 7
    s_nop 3
    v_max3_f32 v2, v2, v68, v69
    v_max3_f32 v2, v2, v70, v71
    v_max3_f32 v2, v2, v72, v73
    v_max3_f32 v2, v2, v74, v75
    v_max3_f32 v2, v2, v76, v77
    v_max3_f32 v2, v2, v78, v79
    v_max3_f32 v2, v2, v80, v81
    v_max3_f32 v2, v2, v82, v83
    v_max3_f32 v2, v2, v84, v85
    v_max3_f32 v2, v2, v86, v87
    v_max3_f32 v2, v2, v88, v89
    v_max3_f32 v2, v2, v90, v91
    v_max3_f32 v2, v2, v92, v93
    v_max3_f32 v2, v2, v94, v95
    v_max3_f32 v2, v2, v96, v97
    v_max3_f32 v2, v2, v98, v99
    v_max3_f32 v3, v3, v132, v133
    v_max3_f32 v3, v3, v134, v135
    v_max3_f32 v3, v3, v136, v137
    v_max3_f32 v3, v3, v138, v139
    v_max3_f32 v3, v3, v140, v141
    v_max3_f32 v3, v3, v142, v143
    v_max3_f32 v3, v3, v144, v145
    v_max3_f32 v3, v3, v146, v147
    v_max3_f32 v3, v3, v148, v149
    v_max3_f32 v3, v3, v150, v151
    v_max3_f32 v3, v3, v152, v153
    v_max3_f32 v3, v3, v154, v155
    v_max3_f32 v3, v3, v156, v157
    v_max3_f32 v3, v3, v158, v159
    v_max3_f32 v3, v3, v160, v161
    v_max3_f32 v3, v3, v162, v163
    s_add_u32 s46, s46, 1
    s_cmp_lt_u32 s46, 4
    s_cbranch_scc1 p2_mx_pair
    s_barrier
    s_add_u32 s45, s45, 1
    s_cmp_lt_u32 s45, 8
    s_cbranch_scc1 p2_mx_loop
    s_branch p2_setmax
p1_idle:
    s_mov_b32 s70, -1
    s_waitcnt lgkmcnt(0)
    s_mov_b32 s12, s90
    s_and_b32 s13, s91, 0xffff
    s_mov_b32 s14, 20971520
    s_mov_b32 s15, 0x20000
    s_cmp_lt_u32 s16, 4
    s_cbranch_scc1 p2_C
    v_mov_b32 v5, 163776
    v_pk_mov_b32 v[6:7], 0, 0
    ds_write_b64 v5, v[6:7]
    s_cmp_lg_u32 s2, 120
    s_cbranch_scc1 p2_L
    s_cmp_lg_u32 s16, 4
    s_cbranch_scc1 p2_L
    s_mov_b32 s8, s88
    s_and_b32 s9, s89, 0xffff
    s_mov_b32 s10, 256
    s_mov_b32 s11, 0x20000
    v_and_b32 v1, 63, v0
    v_lshlrev_b32 v1, 8, v1
    v_mov_b32 v2, 0
    v_mov_b32 v3, 1
    s_mov_b32 s30, 13107200
    buffer_store_dword v2, v1, s[12:15], s30 offen sc1
    s_add_u32 s30, s30, 16384
    buffer_store_dword v2, v1, s[12:15], s30 offen sc1
    s_waitcnt vmcnt(0)
    s_mov_b64 exec, 1
    buffer_store_dword v3, v2, s[8:11], 0 offen sc1
    s_mov_b64 exec, -1
p2_L:
    s_lshl_b32 s49, 1, s22
    s_lshl_b32 s20, s17, 2
    s_and_b32 s21, s18, 3
    s_add_u32 s20, s20, s21
    s_lshr_b32 s21, s18, 2
    s_mul_i32 s25, s20, 81920
    s_lshr_b32 s30, s20, 1
    s_mul_i32 s30, s30, 163840
    s_and_b32 s24, s20, 1
    s_mul_i32 s22, s24, 98304
    s_add_u32 s22, s22, s30
    s_lshl_b32 s24, s24, 3
    s_add_u32 s23, s30, s24
    s_add_u32 s23, s23, 65536
    s_mov_b32 s34, -1
    s_mov_b32 s35, 0
    s_mov_b32 s36, 0
    s_mov_b32 s37, -1
    s_mov_b32 s52, 897988541
    s_mov_b32 s53, 0
    s_mov_b32 s67, 0
    v_and_b32 v1, 63, v0
    v_and_b32 v2, 31, v1
    v_lshrrev_b32 v3, 5, v1
    s_and_b32 s30, s16, 3
    s_lshl_b32 s30, s30, 6
    s_lshl_b32 s31, s21, 8
    s_add_u32 s30, s30, s31
    v_add_u32 v4, s30, v2
    v_lshlrev_b32 v13, 4, v4
    v_mul_u32_u24 v12, 32768, v3
    v_add3_u32 v12, s22, v12, v13
    v_add_u32 v13, s23, v13
    s_sub_u32 s45, s16, 4
    s_lshl_b32 s32, s45, 10
    s_mul_i32 s33, s45, 3072
    s_add_u32 s33, s33, 12288
    v_lshlrev_b32 v16, 4, v1
    v_lshlrev_b32 v25, 8, v1
    s_mul_i32 s30, s45, 2560
    v_add_u32 v5, 0, v1
    v_mul_u32_u24 v6, 2731, v5
    v_lshrrev_b32 v6, 16, v6
    v_lshlrev_b32 v6, 6, v6
    v_lshlrev_b32 v5, 4, v5
    v_sub_u32 v5, v5, v6
    v_add_u32 v17, s30, v5
    v_add_u32 v5, 64, v1
    v_mul_u32_u24 v6, 2731, v5
    v_lshrrev_b32 v6, 16, v6
    v_lshlrev_b32 v6, 6, v6
    v_lshlrev_b32 v5, 4, v5
    v_sub_u32 v5, v5, v6
    v_add_u32 v18, s30, v5
    v_add_u32 v5, 128, v1
    v_mul_u32_u24 v6, 2731, v5
    v_lshrrev_b32 v6, 16, v6
    v_lshlrev_b32 v6, 6, v6
    v_lshlrev_b32 v5, 4, v5
    v_sub_u32 v5, v5, v6
    v_add_u32 v19, s30, v5
    s_mov_b32 s26, 4279238655
    s_mov_b32 s27, 4294905855
    s_mov_b32 s28, 268435215
    s_mov_b32 s29, 4279238655
    s_mov_b32 s30, 4294905855
    s_mov_b32 s31, 268435215
    s_add_u32 s38, s25, 5505024
    s_add_u32 s54, s22, s32
    s_add_u32 s54, s54, 2752512
    s_add_u32 s55, s54, 32768
    s_add_u32 s56, s23, s32
    s_and_b32 s56, s56, 0xfffffff0
    s_add_u32 s56, s56, 2752512
    s_mov_b32 s40, 51200
    v_subrev_u32 v4, 256, v0
    v_lshrrev_b32 v5, 1, v4
    v_and_b32 v6, 1, v4
    v_lshrrev_b32 v7, 5, v5
    v_mul_u32_u24 v7, 12288, v7
    v_mul_u32_u24 v5, 384, v5
    v_lshl_add_u32 v5, v6, 4, v5
    v_add_u32 v7, 63808, v7
    v_add_u32 v5, v5, v7
    v_subrev_u32 v6, 1, v6
    v_and_b32 v32, 0x3f803f80, v6
    v_mov_b32 v33, v32
    v_mov_b32 v34, v32
    v_mov_b32 v35, v32
    v_cmp_gt_u32 vcc, 192, v4
    s_and_saveexec_b64 s[94:95], vcc
    s_cbranch_execz p2a_noinit
    ds_write_b128 v5, v[32:35]
p2a_noinit:
    s_mov_b64 exec, -1
    s_getpc_b64 s[64:65]
pc_l:
    s_sub_u32 s64, s64, pc_l-concat_heads__mha_block__linear_attn_block__prompt_kernel
    s_subb_u32 s65, s65, 0
    s_lshl_b32 s41, s45, 13
    s_add_u32 s64, s64, s41
    s_addc_u32 s65, s65, 0
    v_and_b32 v28, 63, v0
    v_lshlrev_b32 v28, 7, v28
    v_mov_b32 v29, s65
    v_add_co_u32 v28, vcc, s64, v28
    s_nop 1
    v_addc_co_u32 v29, vcc, 0, v29, vcc
    v_mov_b32 v6, 63840
    v_pk_mov_b32 v[32:33], 0, 0
    v_pk_mov_b32 v[34:35], 0, 0
    ds_write_b128 v6, v[32:35]
    ds_write_b128 v6, v[32:35] offset:16
    s_lshr_b32 s57, s17, 2
    s_and_b32 s58, s17, 3
    s_lshl_b32 s58, s58, 2
    s_and_b32 s59, s18, 3
    s_add_u32 s58, s58, s59
    s_lshr_b32 s59, s18, 2
    s_mul_i32 s41, s59, 160
    s_mov_b32 s42, 1280
    v_add_u32 v5, 0, v1
    v_mul_u32_u24 v6, 205, v5
    v_lshrrev_b32 v6, 11, v6
    v_mul_u32_u24 v7, 10, v6
    v_sub_u32 v5, v5, v7
    v_lshl_add_u32 v5, v5, 4, s41
    v_lshrrev_b32 v7, 1, v6
    v_and_b32 v7, 4, v7
    v_xor_b32 v6, v6, v7
    v_mad_u32_u24 v20, v6, s42, v5
    v_add_u32 v5, 64, v1
    v_mul_u32_u24 v6, 205, v5
    v_lshrrev_b32 v6, 11, v6
    v_mul_u32_u24 v7, 10, v6
    v_sub_u32 v5, v5, v7
    v_lshl_add_u32 v5, v5, 4, s41
    v_lshrrev_b32 v7, 1, v6
    v_and_b32 v7, 4, v7
    v_xor_b32 v6, v6, v7
    v_mad_u32_u24 v21, v6, s42, v5
    v_add_u32 v5, 128, v1
    v_mul_u32_u24 v6, 205, v5
    v_lshrrev_b32 v6, 11, v6
    v_mul_u32_u24 v7, 10, v6
    v_sub_u32 v5, v5, v7
    v_lshl_add_u32 v5, v5, 4, s41
    v_lshrrev_b32 v7, 1, v6
    v_and_b32 v7, 4, v7
    v_xor_b32 v6, v6, v7
    v_mad_u32_u24 v22, v6, s42, v5
    v_add_u32 v5, 192, v1
    v_mul_u32_u24 v6, 205, v5
    v_lshrrev_b32 v6, 11, v6
    v_mul_u32_u24 v7, 10, v6
    v_sub_u32 v5, v5, v7
    v_lshl_add_u32 v5, v5, 4, s41
    v_lshrrev_b32 v7, 1, v6
    v_and_b32 v7, 4, v7
    v_xor_b32 v6, v6, v7
    v_mad_u32_u24 v23, v6, s42, v5
    v_add_u32 v5, 256, v1
    v_mul_u32_u24 v6, 205, v5
    v_lshrrev_b32 v6, 11, v6
    v_mul_u32_u24 v7, 10, v6
    v_sub_u32 v5, v5, v7
    v_lshl_add_u32 v5, v5, 4, s41
    v_lshrrev_b32 v7, 1, v6
    v_and_b32 v7, 4, v7
    v_xor_b32 v6, v6, v7
    v_mad_u32_u24 v24, v6, s42, v5
    s_mul_i32 s41, s20, 20
    s_add_u32 s42, s41, 19
    s_lshr_b32 s94, s41, 7
    s_lshr_b32 s95, s42, 7
    s_lshl_b32 s41, 1, s94
    s_lshl_b32 s42, 1, s95
    s_or_b32 s41, s41, s42
    s_mul_i32 s50, s41, 1057
    s_mov_b32 s51, 0
    s_mul_i32 s42, s20, 43
    s_lshr_b32 s42, s42, 7
    s_lshl_b32 s42, 32, s42
    s_or_b32 s41, s41, s42
    s_lshl_b32 s68, s41, 16
    s_mov_b32 s69, 0
    s_mov_b32 s44, s45
    s_lshl_b32 s66, s21, 2
    s_lshr_b32 s41, s20, 3
    s_add_u32 s66, s66, s41
    s_add_u32 s66, s66, 32
    s_mov_b32 s71, 13107200
    s_cmp_lg_u32 s45, 0
    s_cbranch_scc1 p2_L1
    s_mov_b32 s8, s88
    s_and_b32 s9, s89, 0xffff
    s_mov_b32 s10, 256
    s_mov_b32 s11, 0x20000
    s_mov_b64 exec, 1
    s_mov_b32 s41, 65536
p2_pz:
    buffer_load_dword v7, v25, s[8:11], 0 offen sc1
    s_waitcnt vmcnt(0)
    v_cmp_gt_u32 vcc, 1, v7
    s_sub_u32 s41, s41, 1
    s_cbranch_scc1 p2_pz_done
    s_cmp_eq_u64 vcc, 0
    s_cbranch_scc1 p2_pz_done
    s_sleep 2
    s_branch p2_pz
p2_pz_done:
    s_mov_b64 exec, -1
p2_L1:
    s_cmp_ge_u32 s17, 4
    s_cselect_b32 s92, s96, s92
    s_cselect_b32 s93, s97, s93
    s_mov_b32 s8, s92
    s_and_b32 s9, s93, 0xffff
    s_mov_b32 s10, 819200
    s_mov_b32 s11, 0x20000
    v_lshlrev_b32 v14, 4, v2
    v_add_u32 v15, 1344, v14
    v_mul_u32_u24 v5, 672, v3
    v_add_u32 v14, v14, v5
    s_lshl_b32 s46, s45, 8
    s_add_u32 s46, s46, s20
    s_mul_i32 s46, s46, 1680
    s_add_u32 s46, s46, 11010048
    s_mul_i32 s41, s45, 3072
    v_add_u32 v26, 151552, v16
    v_add_u32 v27, s41, v26
    s_lshr_b32 s41, s58, 1
    s_lshl_b32 s41, s41, 10
    s_lshl_b32 s42, s57, 13
    s_add_u32 s41, s41, s42
    s_add_u32 s39, s41, 13115392
    s_mov_b32 s92, 0
    s_mov_b32 s93, 63856
    s_mov_b32 s47, 8257536
    s_mov_b32 s48, 16515072
    s_mov_b32 s60, 0x1fffff
    s_mov_b32 s61, 0x1fffff
    s_mov_b32 s62, 0x1fffff
    s_mov_b32 s63, 0
    v_pk_mov_b32 v[32:33], 0, 0
    v_pk_mov_b32 v[34:35], 0, 0
    v_pk_mov_b32 v[36:37], 0, 0
    v_pk_mov_b32 v[38:39], 0, 0
    v_pk_mov_b32 v[40:41], 0, 0
    v_pk_mov_b32 v[42:43], 0, 0
    v_pk_mov_b32 v[44:45], 0, 0
    v_pk_mov_b32 v[46:47], 0, 0
    v_pk_mov_b32 v[48:49], 0, 0
    v_pk_mov_b32 v[50:51], 0, 0
    v_pk_mov_b32 v[52:53], 0, 0
    v_pk_mov_b32 v[54:55], 0, 0
    v_pk_mov_b32 v[56:57], 0, 0
    v_pk_mov_b32 v[58:59], 0, 0
    v_pk_mov_b32 v[60:61], 0, 0
    v_pk_mov_b32 v[62:63], 0, 0
    v_pk_mov_b32 v[64:65], 0, 0
    v_pk_mov_b32 v[66:67], 0, 0
    v_pk_mov_b32 v[68:69], 0, 0
    v_pk_mov_b32 v[70:71], 0, 0
    v_pk_mov_b32 v[72:73], 0, 0
    v_pk_mov_b32 v[74:75], 0, 0
    v_pk_mov_b32 v[76:77], 0, 0
    v_pk_mov_b32 v[78:79], 0, 0
    v_pk_mov_b32 v[80:81], 0, 0
    v_pk_mov_b32 v[82:83], 0, 0
    v_pk_mov_b32 v[84:85], 0, 0
    v_pk_mov_b32 v[86:87], 0, 0
    v_pk_mov_b32 v[88:89], 0, 0
    v_pk_mov_b32 v[90:91], 0, 0
    v_pk_mov_b32 v[92:93], 0, 0
    v_pk_mov_b32 v[94:95], 0, 0
    v_pk_mov_b32 v[96:97], 0, 0
    v_pk_mov_b32 v[98:99], 0, 0
    v_pk_mov_b32 v[100:101], 0, 0
    v_pk_mov_b32 v[102:103], 0, 0
    v_pk_mov_b32 v[104:105], 0, 0
    v_pk_mov_b32 v[106:107], 0, 0
    v_pk_mov_b32 v[108:109], 0, 0
    v_pk_mov_b32 v[110:111], 0, 0
    v_pk_mov_b32 v[112:113], 0, 0
    v_pk_mov_b32 v[114:115], 0, 0
    v_pk_mov_b32 v[116:117], 0, 0
    v_pk_mov_b32 v[118:119], 0, 0
    v_pk_mov_b32 v[120:121], 0, 0
    v_pk_mov_b32 v[122:123], 0, 0
    v_pk_mov_b32 v[124:125], 0, 0
    v_pk_mov_b32 v[126:127], 0, 0
    v_pk_mov_b32 v[132:133], 0, 0
    v_pk_mov_b32 v[138:139], 0, 0
    s_setprio 1
    s_mov_b32 s88, 0
    s_mov_b32 s89, 0
    s_mov_b32 s90, s94
    s_mov_b32 s91, s95
    s_sub_u32 s64, s70, 16
    s_cmp_lt_u32 s64, 16
    s_cbranch_scc1 p2_first
p2_Lx1:
    s_waitcnt lgkmcnt(0)
    s_barrier
    s_cmp_lt_u32 s64, 16
    s_cbranch_scc1 p2_L2
p2_first:
    v_mov_b32 v5, 163776
    s_cmp_lg_u32 s45, 0
    s_cbranch_scc1 p2_spin
    s_cmp_lt_u32 s70, 16
    s_cbranch_scc0 p2_nosig
    s_lshl_b32 s41, s70, 8
    s_add_u32 s41, s41, 13107200
    v_mov_b32 v6, 0
    v_mov_b32 v7, s49
    s_mov_b64 exec, 1
    buffer_atomic_or v7, v6, s[12:15], s41 offen sc1
    s_mov_b64 exec, -1
p2_nosig:
    s_mov_b32 s99, 65536
p2_pa:
    s_mov_b64 exec, s[50:51]
    buffer_load_dword v7, v25, s[12:15], s71 offen sc1
    s_add_u32 s96, s90, 5
    s_add_u32 s97, s91, 5
    s_waitcnt vmcnt(0)
    s_mov_b64 exec, -1
    v_readlane_b32 s88, v7, s96
    v_readlane_b32 s98, v7, s97
    s_add_u32 s96, s90, 10
    s_add_u32 s97, s91, 10
    s_and_b32 s88, s88, s98
    v_readlane_b32 s98, v7, s96
    v_readlane_b32 s96, v7, s97
    s_nop 0
    s_and_b32 s88, s88, s98
    s_and_b32 s88, s88, s96
    v_readlane_b32 s96, v7, s90
    v_readlane_b32 s97, v7, s91
    s_nop 0
    s_and_b32 s96, s96, s97
    s_bitcmp1_b32 s96, s21
    s_cselect_b32 s88, s88, 0
    s_sub_u32 s99, s99, 1
    s_cselect_b32 s88, 255, s88
    s_andn2_b32 s96, s88, s89
    s_cbranch_scc1 p2_pa_done
    s_sleep 2
    s_branch p2_pa
p2_pa_done:
    s_ff1_i32_b32 s19, s96
    s_bitset1_b32 s89, s19
    s_add_u32 s96, s19, 1
    v_mov_b32 v7, s96
    ds_write_b32 v5, v7
    s_branch p2_go
p2_spin:
    ds_read_b32 v7, v5 offset:0
    s_waitcnt lgkmcnt(0)
    v_readfirstlane_b32 s19, v7
    s_sleep 1
    s_sub_u32 s19, s19, 1
    s_cbranch_scc1 p2_spin
p2_go:
    s_lshl_b32 s41, s21, 12
    s_sub_u32 s41, s41, 2752512
    s_add_u32 m0, s32, 100352
    s_add_u32 s42, s54, s41
    buffer_load_dwordx4 v16, s[12:15], s42 offen sc1 lds
    s_add_u32 m0, s32, 104448
    s_add_u32 s42, s55, s41
    buffer_load_dwordx4 v16, s[12:15], s42 offen sc1 lds
    s_add_u32 m0, s32, 108544
    s_add_u32 s42, s56, s41
    buffer_load_dwordx4 v16, s[12:15], s42 offen sc1 lds
    s_add_u32 s41, s40, s32
    s_add_u32 s42, s40, s33
    s_lshl_b32 s96, s19, 12
    s_mul_i32 s97, s19, 10240
    s_add_u32 s97, s97, s38
    s_add_u32 m0, s41, 0
    s_add_u32 s98, s54, s96
    s_mov_b64 exec, -1
    buffer_load_dwordx4 v16, s[12:15], s98 offen sc1 lds
    s_add_u32 m0, s42, 0
    s_mov_b64 exec, s[26:27]
    buffer_load_dwordx4 v17, s[12:15], s97 offen sc1 lds
    s_add_u32 m0, s41, 4096
    s_add_u32 s98, s55, s96
    s_mov_b64 exec, -1
    buffer_load_dwordx4 v16, s[12:15], s98 offen sc1 lds
    s_add_u32 m0, s42, 1024
    s_mov_b64 exec, s[28:29]
    buffer_load_dwordx4 v18, s[12:15], s97 offen sc1 lds
    s_add_u32 m0, s41, 8192
    s_add_u32 s98, s56, s96
    s_mov_b64 exec, -1
    buffer_load_dwordx4 v16, s[12:15], s98 offen sc1 lds
    s_add_u32 m0, s42, 2048
    s_mov_b64 exec, s[30:31]
    buffer_load_dwordx4 v19, s[12:15], s97 offen sc1 lds
    s_mov_b64 exec, -1
    s_add_u32 s40, s40, 24576
    s_cmp_eq_u32 s40, 124928
    s_cselect_b32 s40, 51200, s40
    s_cmp_lt_u32 s64, 16
    s_cbranch_scc1 p2_Lx1
p2_L2:
    s_waitcnt vmcnt(0) lgkmcnt(0)
    s_barrier
    s_cmp_lg_u32 s45, 0
    s_cbranch_scc1 p2_spin1
    s_mov_b32 s99, 65536
p2_pa1:
    s_andn2_b32 s96, s88, s89
    s_cbranch_scc1 p2_pa1_done
    s_mov_b64 exec, s[50:51]
    buffer_load_dword v7, v25, s[12:15], s71 offen sc1
    s_add_u32 s96, s90, 5
    s_add_u32 s97, s91, 5
    s_waitcnt vmcnt(0)
    s_mov_b64 exec, -1
    v_readlane_b32 s88, v7, s96
    v_readlane_b32 s98, v7, s97
    s_add_u32 s96, s90, 10
    s_add_u32 s97, s91, 10
    s_and_b32 s88, s88, s98
    v_readlane_b32 s98, v7, s96
    v_readlane_b32 s96, v7, s97
    s_nop 0
    s_and_b32 s88, s88, s98
    s_and_b32 s88, s88, s96
    s_sub_u32 s99, s99, 1
    s_cselect_b32 s88, 255, s88
    s_andn2_b32 s96, s88, s89
    s_cbranch_scc1 p2_pa1_done
    s_sleep 2
    s_branch p2_pa1
p2_pa1_done:
    s_ff1_i32_b32 s19, s96
    s_bitset1_b32 s89, s19
    s_add_u32 s96, s19, 1
    v_mov_b32 v7, s96
    ds_write_b32 v5, v7 offset:4
    s_branch p2_go1
p2_spin1:
    ds_read_b32 v7, v5 offset:4
    s_waitcnt lgkmcnt(0)
    v_readfirstlane_b32 s19, v7
    s_sleep 1
    s_sub_u32 s19, s19, 1
    s_cbranch_scc1 p2_spin1
p2_go1:
    v_mov_b32 v31, 63848
    s_add_u32 s41, s40, s32
    s_add_u32 s42, s40, s33
    s_lshl_b32 s96, s19, 12
    s_mul_i32 s97, s19, 10240
    s_add_u32 s97, s97, s38
    s_add_u32 m0, s41, 0
    s_add_u32 s98, s54, s96
    s_mov_b64 exec, -1
    buffer_load_dwordx4 v16, s[12:15], s98 offen sc1 lds
    s_add_u32 m0, s42, 0
    s_mov_b64 exec, s[26:27]
    buffer_load_dwordx4 v17, s[12:15], s97 offen sc1 lds
    s_add_u32 m0, s41, 4096
    s_add_u32 s98, s55, s96
    s_mov_b64 exec, -1
    buffer_load_dwordx4 v16, s[12:15], s98 offen sc1 lds
    s_add_u32 m0, s42, 1024
    s_mov_b64 exec, s[28:29]
    buffer_load_dwordx4 v18, s[12:15], s97 offen sc1 lds
    s_add_u32 m0, s41, 8192
    s_add_u32 s98, s56, s96
    s_mov_b64 exec, -1
    buffer_load_dwordx4 v16, s[12:15], s98 offen sc1 lds
    s_add_u32 m0, s42, 2048
    s_mov_b64 exec, s[30:31]
    buffer_load_dwordx4 v19, s[12:15], s97 offen sc1 lds
    s_mov_b64 exec, -1
    s_add_u32 s40, s40, 24576
    s_cmp_eq_u32 s40, 124928
    s_cselect_b32 s40, 51200, s40
    s_mul_i32 s41, s44, 5120
    s_cmp_ge_u32 s44, 10
    s_cselect_b32 s42, 74752, 0
    s_cmp_ge_u32 s44, 15
    s_cselect_b32 s42, 23552, s42
    s_add_u32 s41, s41, s42
    s_mul_i32 s42, s44, 40960
    s_add_u32 m0, s41, 0
    s_nop 0
    buffer_load_dwordx4 v20, s[8:11], s42 offen lds
    s_add_u32 m0, s41, 1024
    s_nop 0
    buffer_load_dwordx4 v21, s[8:11], s42 offen lds
    s_add_u32 m0, s41, 2048
    s_nop 0
    buffer_load_dwordx4 v22, s[8:11], s42 offen lds
    s_add_u32 m0, s41, 3072
    s_nop 0
    buffer_load_dwordx4 v23, s[8:11], s42 offen lds
    s_add_u32 m0, s41, 4096
    s_nop 0
    buffer_load_dwordx4 v24, s[8:11], s42 offen lds
    s_add_u32 s44, s44, 4
    s_mov_b32 s43, 0
p2_hloop:
    s_cmp_lg_u32 s45, 0
    s_cbranch_scc1 p2_hb
    s_cmp_ge_u32 s43, 6
    s_cbranch_scc1 p2_hb
    s_mov_b32 s99, 65536
p2_pa2:
    s_andn2_b32 s96, s88, s89
    s_cbranch_scc1 p2_pa2_done
    s_mov_b64 exec, s[50:51]
    buffer_load_dword v7, v25, s[12:15], s71 offen sc1
    s_add_u32 s96, s90, 5
    s_add_u32 s97, s91, 5
    s_waitcnt vmcnt(0)
    s_mov_b64 exec, -1
    v_readlane_b32 s88, v7, s96
    v_readlane_b32 s98, v7, s97
    s_add_u32 s96, s90, 10
    s_add_u32 s97, s91, 10
    s_and_b32 s88, s88, s98
    v_readlane_b32 s98, v7, s96
    v_readlane_b32 s96, v7, s97
    s_nop 0
    s_and_b32 s88, s88, s98
    s_and_b32 s88, s88, s96
    s_sub_u32 s99, s99, 1
    s_cselect_b32 s88, 255, s88
    s_andn2_b32 s96, s88, s89
    s_cbranch_scc1 p2_pa2_done
    s_sleep 2
    s_branch p2_pa2
p2_pa2_done:
    s_ff1_i32_b32 s19, s96
    s_bitset1_b32 s89, s19
    v_mov_b32 v7, s19
    ds_write_b32 v31, v7
p2_hb:
    s_waitcnt vmcnt(4) lgkmcnt(0)
    s_barrier
    s_cmp_ge_u32 s43, 6
    s_cbranch_scc1 p2_hw
    ds_read_b32 v7, v31
    v_xor_b32 v31, 4, v31
    s_waitcnt lgkmcnt(0)
    v_readfirstlane_b32 s19, v7
    s_add_u32 s41, s40, s32
    s_add_u32 s42, s40, s33
    s_lshl_b32 s96, s19, 12
    s_mul_i32 s97, s19, 10240
    s_add_u32 s97, s97, s38
    s_add_u32 m0, s41, 0
    s_add_u32 s98, s54, s96
    s_mov_b64 exec, -1
    buffer_load_dwordx4 v16, s[12:15], s98 offen sc1 lds
    s_add_u32 m0, s42, 0
    s_mov_b64 exec, s[26:27]
    buffer_load_dwordx4 v17, s[12:15], s97 offen sc1 lds
    s_add_u32 m0, s41, 4096
    s_add_u32 s98, s55, s96
    s_mov_b64 exec, -1
    buffer_load_dwordx4 v16, s[12:15], s98 offen sc1 lds
    s_add_u32 m0, s42, 1024
    s_mov_b64 exec, s[28:29]
    buffer_load_dwordx4 v18, s[12:15], s97 offen sc1 lds
    s_add_u32 m0, s41, 8192
    s_add_u32 s98, s56, s96
    s_mov_b64 exec, -1
    buffer_load_dwordx4 v16, s[12:15], s98 offen sc1 lds
    s_add_u32 m0, s42, 2048
    s_mov_b64 exec, s[30:31]
    buffer_load_dwordx4 v19, s[12:15], s97 offen sc1 lds
    s_mov_b64 exec, -1
    s_add_u32 s40, s40, 24576
    s_cmp_eq_u32 s40, 124928
    s_cselect_b32 s40, 51200, s40
    s_cmp_lg_u32 s53, 0
    s_cbranch_scc1 p2_hdrain
    s_cmp_eq_u32 s43, 2
    s_cbranch_scc1 p2_lin1
    s_cmp_eq_u32 s43, 3
    s_cbranch_scc1 p2_lin2
    s_cmp_eq_u32 s43, 1
    s_cbranch_scc1 p2_hpoll
    s_cmp_lg_u32 s43, 5
    s_cbranch_scc1 p2_hw
    s_cmp_lg_u32 s45, 0
    s_cbranch_scc1 p2_hw5
    s_add_u32 s65, s66, 32
    s_lshl_b32 s41, s65, 8
    s_add_u32 s41, s41, 13107200
    v_mov_b32 v6, 0
    v_mov_b32 v7, 1
    s_mov_b64 exec, 1
    buffer_atomic_add v7, v6, s[12:15], s41 offen sc1
    s_mov_b64 exec, -1
p2_hw5:
    s_and_b32 s41, s18, 7
    s_cmp_lg_u32 s41, 0
    s_cbranch_scc1 p2_noic
    global_load_dword v30, v[28:29], off
p2_noic:
    s_nop 0
    s_cmp_lg_u32 s44, 15
    s_cbranch_scc1 p2_hw
    s_mov_b32 s44, 19
    s_branch p2_hdrain
p2_hw:
    s_mul_i32 s41, s44, 5120
    s_cmp_ge_u32 s44, 10
    s_cselect_b32 s42, 74752, 0
    s_cmp_ge_u32 s44, 15
    s_cselect_b32 s42, 23552, s42
    s_add_u32 s41, s41, s42
    s_mul_i32 s42, s44, 40960
    s_add_u32 m0, s41, 0
    s_nop 0
    buffer_load_dwordx4 v20, s[8:11], s42 offen lds
    s_add_u32 m0, s41, 1024
    s_nop 0
    buffer_load_dwordx4 v21, s[8:11], s42 offen lds
    s_add_u32 m0, s41, 2048
    s_nop 0
    buffer_load_dwordx4 v22, s[8:11], s42 offen lds
    s_add_u32 m0, s41, 3072
    s_nop 0
    buffer_load_dwordx4 v23, s[8:11], s42 offen lds
    s_add_u32 m0, s41, 4096
    s_nop 0
    buffer_load_dwordx4 v24, s[8:11], s42 offen lds
    s_add_u32 s44, s44, 4
    s_cmp_eq_u32 s44, 23
    s_cselect_b32 s44, 15, s44
    s_cbranch_scc1 p2_hw
    s_or_b32 s41, s43, s45
    s_cmp_lg_u32 s41, 0
    s_cbranch_scc1 p2_hnext
    s_sub_u32 s41, s70, 16
    s_cmp_lt_u32 s41, 16
    s_cbranch_scc0 p2_hnext
    s_lshl_b32 s41, s70, 8
    s_add_u32 s41, s41, 13107200
    v_mov_b32 v6, 0
    v_mov_b32 v7, 1
    s_mov_b64 exec, 1
    buffer_atomic_add v7, v6, s[12:15], s41 offen sc1
    s_mov_b64 exec, -1
    s_branch p2_hnext
p2_hpoll:
    s_cmp_lg_u32 s45, 0
    s_cbranch_scc1 p2_hdrain
    s_mov_b64 exec, s[68:69]
    s_mov_b32 s41, 65536
p2_pb:
    buffer_load_dword v7, v25, s[12:15], s71 offen sc1
    s_waitcnt vmcnt(0)
    v_cmp_gt_u32 vcc, 8, v7
    s_sub_u32 s41, s41, 1
    s_cbranch_scc1 p2_pb_done
    s_cmp_eq_u64 vcc, 0
    s_cbranch_scc1 p2_pb_done
    s_sleep 2
    s_branch p2_pb
p2_pb_done:
    s_mov_b64 exec, -1
p2_hdrain:
    s_waitcnt vmcnt(0)
p2_hnext:
    s_add_u32 s43, s43, 1
    s_cmp_lt_u32 s43, 7
    s_cbranch_scc1 p2_hloop
    s_barrier
    v_mov_b32 v4, 63840
    v_mov_b32 v5, 1
    s_waitcnt vmcnt(0)
    s_mov_b64 exec, 1
    ds_add_u32 v4, v5
    s_mov_b64 exec, -1
    s_cmp_eq_u32 s45, 1
    s_cbranch_scc1 p3_pub
p3_pf:
    s_mov_b64 exec, -1
    s_lshl_b32 s40, 8, s53
p3_vl:
    ds_read_b32 v7, v4
    s_waitcnt lgkmcnt(0)
    v_readfirstlane_b32 s41, v7
    s_sleep 3
    s_and_b32 s42, s41, 255
    s_cmp_lt_u32 s42, s40
    s_cbranch_scc1 p3_vl
    s_lshr_b32 s41, s41, 8
    s_andn2_b32 s41, s41, s67
    s_cmp_lg_u32 s41, 0
    s_cbranch_scc1 p2_hfallback
    s_cmp_lg_u32 s45, 0
    s_cbranch_scc1 p3_L1
p3_dw:
    ds_read_b32 v7, v4 offset:4
    s_waitcnt lgkmcnt(0)
    v_readfirstlane_b32 s41, v7
    s_sleep 1
    s_cmp_lt_u32 s41, 4
    s_cbranch_scc1 p3_dw
    s_lshl_b32 s41, s66, 8
    s_add_u32 s41, s41, 13107200
    v_mov_b32 v6, 0
    v_mov_b32 v7, 1
    s_mov_b64 exec, 1
    buffer_atomic_add v7, v6, s[12:15], s41 offen sc1
    s_mov_b64 exec, -1
    s_branch p3_L1
p3_pub:
    s_mov_b32 s43, 65536
    s_lshl_b32 s40, 8, s53
    s_mov_b64 exec, 15
p3_p:
    buffer_load_dword v7, v25, s[12:15], s39 offen sc1
    ds_read_b32 v3, v4
    s_waitcnt vmcnt(0) lgkmcnt(0)
    v_cmp_le_u32 vcc, 8, v7
    v_readfirstlane_b32 s64, v3
    s_sub_u32 s43, s43, 1
    s_cselect_b32 s41, 15, vcc_lo
    s_andn2_b32 s41, s41, s92
p3_pn:
    s_ff1_i32_b32 s42, s41
    s_cmp_eq_u32 s42, -1
    s_cbranch_scc1 p3_pe
    s_bitset0_b32 s41, s42
    s_bitset1_b32 s92, s42
    s_add_u32 s42, s42, 1
    v_mov_b32 v6, s93
    v_mov_b32 v5, s42
    ds_write_b32 v6, v5
    s_add_u32 s93, s93, 4
    s_branch p3_pn
p3_pe:
    s_and_b32 s42, s64, 255
    s_cmp_lt_u32 s42, s40
    s_cbranch_scc0 p3_pc
    s_cmp_eq_u32 s92, 15
    s_cbranch_scc1 p3_pf
    s_sleep 12
    s_branch p3_p
p3_pc:
    s_lshr_b32 s64, s64, 8
    s_andn2_b32 s64, s64, s67
    s_cmp_lg_u32 s64, 0
    s_cbranch_scc1 p2_hfallback
    s_sleep 1
    s_cmp_lg_u32 s92, 15
    s_cbranch_scc1 p3_p
    s_mov_b64 exec, -1
    s_waitcnt lgkmcnt(0)
p3_L1:
    s_endpgm
p2_lin1:
    buffer_load_dwordx4 v[128:131], v12, s[12:15], s47 offen offset:0 sc1
    buffer_load_dwordx4 v[134:137], v12, s[12:15], s47 offen offset:512 sc1
    s_mov_b64 exec, s[34:35]
    buffer_load_dwordx2 v[132:133], v13, s[12:15], s47 offen offset:0 sc1
    buffer_load_dwordx2 v[138:139], v13, s[12:15], s47 offen offset:512 sc1
    s_mov_b64 exec, s[60:61]
    buffer_load_dwordx4 v[32:35], v14, s[12:15], s46 offen sc1
    buffer_load_dwordx4 v[36:39], v14, s[12:15], s46 offen offset:336 sc1
    s_mov_b64 exec, s[62:63]
    buffer_load_dwordx4 v[40:43], v15, s[12:15], s46 offen sc1
    s_add_u32 s46, s46, 53760
    s_mov_b64 exec, s[60:61]
    buffer_load_dwordx4 v[44:47], v14, s[12:15], s46 offen sc1
    buffer_load_dwordx4 v[48:51], v14, s[12:15], s46 offen offset:336 sc1
    s_mov_b64 exec, s[62:63]
    buffer_load_dwordx4 v[52:55], v15, s[12:15], s46 offen sc1
    s_add_u32 s46, s46, 53760
    s_mov_b64 exec, s[60:61]
    buffer_load_dwordx4 v[56:59], v14, s[12:15], s46 offen sc1
    buffer_load_dwordx4 v[60:63], v14, s[12:15], s46 offen offset:336 sc1
    s_mov_b64 exec, s[62:63]
    buffer_load_dwordx4 v[64:67], v15, s[12:15], s46 offen sc1
    s_add_u32 s46, s46, 53760
    s_mov_b64 exec, s[60:61]
    buffer_load_dwordx4 v[68:71], v14, s[12:15], s46 offen sc1
    buffer_load_dwordx4 v[72:75], v14, s[12:15], s46 offen offset:336 sc1
    s_mov_b64 exec, s[62:63]
    buffer_load_dwordx4 v[76:79], v15, s[12:15], s46 offen sc1
    s_add_u32 s46, s46, 53760
    s_mov_b64 exec, s[60:61]
    buffer_load_dwordx4 v[80:83], v14, s[12:15], s46 offen sc1
    buffer_load_dwordx4 v[84:87], v14, s[12:15], s46 offen offset:336 sc1
    s_mov_b64 exec, s[62:63]
    buffer_load_dwordx4 v[88:91], v15, s[12:15], s46 offen sc1
    s_add_u32 s46, s46, 53760
    s_mov_b64 exec, s[60:61]
    buffer_load_dwordx4 v[92:95], v14, s[12:15], s46 offen sc1
    buffer_load_dwordx4 v[96:99], v14, s[12:15], s46 offen offset:336 sc1
    s_mov_b64 exec, s[62:63]
    buffer_load_dwordx4 v[100:103], v15, s[12:15], s46 offen sc1
    s_add_u32 s46, s46, 53760
    s_mov_b64 exec, s[60:61]
    buffer_load_dwordx4 v[104:107], v14, s[12:15], s46 offen sc1
    buffer_load_dwordx4 v[108:111], v14, s[12:15], s46 offen offset:336 sc1
    s_mov_b64 exec, s[62:63]
    buffer_load_dwordx4 v[112:115], v15, s[12:15], s46 offen sc1
    s_add_u32 s46, s46, 53760
    s_mov_b64 exec, s[60:61]
    buffer_load_dwordx4 v[116:119], v14, s[12:15], s46 offen sc1
    buffer_load_dwordx4 v[120:123], v14, s[12:15], s46 offen offset:336 sc1
    s_mov_b64 exec, s[62:63]
    buffer_load_dwordx4 v[124:127], v15, s[12:15], s46 offen sc1
    s_add_u32 s46, s46, 53760
    s_mov_b64 exec, -1
    s_waitcnt vmcnt(18)
    v_pk_add_f32 v[32:33], v[32:33], v[44:45]
    v_pk_add_f32 v[34:35], v[34:35], v[46:47]
    v_pk_add_f32 v[36:37], v[36:37], v[48:49]
    v_pk_add_f32 v[38:39], v[38:39], v[50:51]
    v_pk_add_f32 v[40:41], v[40:41], v[52:53]
    v_pk_add_f32 v[42:43], v[42:43], v[54:55]
    s_waitcnt vmcnt(15)
    v_pk_add_f32 v[32:33], v[32:33], v[56:57]
    v_pk_add_f32 v[34:35], v[34:35], v[58:59]
    v_pk_add_f32 v[36:37], v[36:37], v[60:61]
    v_pk_add_f32 v[38:39], v[38:39], v[62:63]
    v_pk_add_f32 v[40:41], v[40:41], v[64:65]
    v_pk_add_f32 v[42:43], v[42:43], v[66:67]
    s_waitcnt vmcnt(12)
    v_pk_add_f32 v[32:33], v[32:33], v[68:69]
    v_pk_add_f32 v[34:35], v[34:35], v[70:71]
    v_pk_add_f32 v[36:37], v[36:37], v[72:73]
    v_pk_add_f32 v[38:39], v[38:39], v[74:75]
    v_pk_add_f32 v[40:41], v[40:41], v[76:77]
    v_pk_add_f32 v[42:43], v[42:43], v[78:79]
    s_waitcnt vmcnt(9)
    v_pk_add_f32 v[32:33], v[32:33], v[80:81]
    v_pk_add_f32 v[34:35], v[34:35], v[82:83]
    v_pk_add_f32 v[36:37], v[36:37], v[84:85]
    v_pk_add_f32 v[38:39], v[38:39], v[86:87]
    v_pk_add_f32 v[40:41], v[40:41], v[88:89]
    v_pk_add_f32 v[42:43], v[42:43], v[90:91]
    s_waitcnt vmcnt(6)
    v_pk_add_f32 v[32:33], v[32:33], v[92:93]
    v_pk_add_f32 v[34:35], v[34:35], v[94:95]
    v_pk_add_f32 v[36:37], v[36:37], v[96:97]
    v_pk_add_f32 v[38:39], v[38:39], v[98:99]
    v_pk_add_f32 v[40:41], v[40:41], v[100:101]
    v_pk_add_f32 v[42:43], v[42:43], v[102:103]
    s_waitcnt vmcnt(3)
    v_pk_add_f32 v[32:33], v[32:33], v[104:105]
    v_pk_add_f32 v[34:35], v[34:35], v[106:107]
    v_pk_add_f32 v[36:37], v[36:37], v[108:109]
    v_pk_add_f32 v[38:39], v[38:39], v[110:111]
    v_pk_add_f32 v[40:41], v[40:41], v[112:113]
    v_pk_add_f32 v[42:43], v[42:43], v[114:115]
    s_waitcnt vmcnt(0)
    v_pk_add_f32 v[32:33], v[32:33], v[116:117]
    v_pk_add_f32 v[34:35], v[34:35], v[118:119]
    v_pk_add_f32 v[36:37], v[36:37], v[120:121]
    v_pk_add_f32 v[38:39], v[38:39], v[122:123]
    v_pk_add_f32 v[40:41], v[40:41], v[124:125]
    v_pk_add_f32 v[42:43], v[42:43], v[126:127]
    ds_write_b128 v27, v[32:35] offset:0
    ds_write_b128 v27, v[36:39] offset:1024
    ds_write_b128 v27, v[40:43] offset:2048
    s_waitcnt lgkmcnt(0)
    s_branch p2_hnext
p2_lin2:
    ds_read_b128 v[32:35], v26 offset:0
    ds_read_b128 v[36:39], v26 offset:1024
    ds_read_b128 v[40:43], v26 offset:2048
    ds_read_b128 v[44:47], v26 offset:3072
    ds_read_b128 v[48:51], v26 offset:4096
    ds_read_b128 v[52:55], v26 offset:5120
    ds_read_b128 v[56:59], v26 offset:6144
    ds_read_b128 v[60:63], v26 offset:7168
    ds_read_b128 v[64:67], v26 offset:8192
    ds_read_b128 v[68:71], v26 offset:9216
    ds_read_b128 v[72:75], v26 offset:10240
    ds_read_b128 v[76:79], v26 offset:11264
    s_waitcnt lgkmcnt(6)
    v_pk_add_f32 v[32:33], v[32:33], v[44:45]
    v_pk_add_f32 v[34:35], v[34:35], v[46:47]
    v_pk_add_f32 v[36:37], v[36:37], v[48:49]
    v_pk_add_f32 v[38:39], v[38:39], v[50:51]
    v_pk_add_f32 v[40:41], v[40:41], v[52:53]
    v_pk_add_f32 v[42:43], v[42:43], v[54:55]
    s_waitcnt lgkmcnt(3)
    v_pk_add_f32 v[32:33], v[32:33], v[56:57]
    v_pk_add_f32 v[34:35], v[34:35], v[58:59]
    v_pk_add_f32 v[36:37], v[36:37], v[60:61]
    v_pk_add_f32 v[38:39], v[38:39], v[62:63]
    v_pk_add_f32 v[40:41], v[40:41], v[64:65]
    v_pk_add_f32 v[42:43], v[42:43], v[66:67]
    s_waitcnt lgkmcnt(0)
    v_pk_add_f32 v[32:33], v[32:33], v[68:69]
    v_pk_add_f32 v[34:35], v[34:35], v[70:71]
    v_pk_add_f32 v[36:37], v[36:37], v[72:73]
    v_pk_add_f32 v[38:39], v[38:39], v[74:75]
    v_pk_add_f32 v[40:41], v[40:41], v[76:77]
    v_pk_add_f32 v[42:43], v[42:43], v[78:79]
    v_cvt_pk_bf16_f32 v32, v32, v33
    v_cvt_pk_bf16_f32 v33, v34, v35
    v_cvt_pk_bf16_f32 v34, v36, v37
    v_cvt_pk_bf16_f32 v35, v38, v39
    v_cvt_pk_bf16_f32 v36, v40, v41
    v_cvt_pk_bf16_f32 v37, v42, v43
    s_nop 1
    v_mfma_f32_32x32x16_bf16 v[48:63], v[32:35], v[128:131], 0
    v_mfma_f32_32x32x8_bf16 v[48:63], v[36:37], v[132:133], v[48:63]
    v_mfma_f32_32x32x16_bf16 v[64:79], v[32:35], v[134:137], 0
    v_mfma_f32_32x32x8_bf16 v[64:79], v[36:37], v[138:139], v[64:79]
    s_nop 7
    s_nop 2
    v_mov_b32 v2, v56
    v_mov_b32 v3, v56
    s_nop 1
    v_permlane32_swap_b32 v2, v3
    s_nop 0
    v_add_f32 v3, s52, v3
    s_nop 0
    v_rcp_f32 v4, v3
    s_nop 0
    v_pk_mul_f32 v[48:49], v[48:49], v[4:5] op_sel_hi:[1,0]
    v_pk_mul_f32 v[50:51], v[50:51], v[4:5] op_sel_hi:[1,0]
    v_pk_mul_f32 v[52:53], v[52:53], v[4:5] op_sel_hi:[1,0]
    v_pk_mul_f32 v[54:55], v[54:55], v[4:5] op_sel_hi:[1,0]
    v_pk_mul_f32 v[56:57], v[56:57], v[4:5] op_sel_hi:[1,0]
    v_pk_mul_f32 v[58:59], v[58:59], v[4:5] op_sel_hi:[1,0]
    v_cvt_pk_bf16_f32 v48, v48, v49
    v_cvt_pk_bf16_f32 v49, v50, v51
    v_cvt_pk_bf16_f32 v50, v52, v53
    v_cvt_pk_bf16_f32 v51, v54, v55
    v_cvt_pk_bf16_f32 v52, v56, v57
    v_cvt_pk_bf16_f32 v53, v58, v59
    s_mov_b64 exec, s[34:35]
    buffer_store_dwordx2 v[52:53], v13, s[12:15], s48 offen offset:0 sc1
    s_mov_b64 exec, -1
    v_permlane32_swap_b32 v48, v50
    v_permlane32_swap_b32 v49, v51
    buffer_store_dwordx4 v[48:51], v12, s[12:15], s48 offen offset:0 sc1
    v_mov_b32 v2, v72
    v_mov_b32 v3, v72
    s_nop 1
    v_permlane32_swap_b32 v2, v3
    s_nop 0
    v_add_f32 v3, s52, v3
    s_nop 0
    v_rcp_f32 v4, v3
    s_nop 0
    v_pk_mul_f32 v[64:65], v[64:65], v[4:5] op_sel_hi:[1,0]
    v_pk_mul_f32 v[66:67], v[66:67], v[4:5] op_sel_hi:[1,0]
    v_pk_mul_f32 v[68:69], v[68:69], v[4:5] op_sel_hi:[1,0]
    v_pk_mul_f32 v[70:71], v[70:71], v[4:5] op_sel_hi:[1,0]
    v_pk_mul_f32 v[72:73], v[72:73], v[4:5] op_sel_hi:[1,0]
    v_pk_mul_f32 v[74:75], v[74:75], v[4:5] op_sel_hi:[1,0]
    v_cvt_pk_bf16_f32 v64, v64, v65
    v_cvt_pk_bf16_f32 v65, v66, v67
    v_cvt_pk_bf16_f32 v66, v68, v69
    v_cvt_pk_bf16_f32 v67, v70, v71
    v_cvt_pk_bf16_f32 v68, v72, v73
    v_cvt_pk_bf16_f32 v69, v74, v75
    s_mov_b64 exec, s[34:35]
    buffer_store_dwordx2 v[68:69], v13, s[12:15], s48 offen offset:512 sc1
    s_mov_b64 exec, -1
    v_permlane32_swap_b32 v64, v66
    v_permlane32_swap_b32 v65, v67
    buffer_store_dwordx4 v[64:67], v12, s[12:15], s48 offen offset:512 sc1
    s_branch p2_hnext
p2_hfallback:
    s_mov_b64 exec, -1
    s_mov_b32 s53, 1
    s_mov_b32 s67, -1
    s_mov_b32 s43, 0
    v_subrev_u32 v4, 256, v0
    v_lshrrev_b32 v5, 1, v4
    v_and_b32 v6, 1, v4
    v_lshrrev_b32 v7, 5, v5
    v_mul_u32_u24 v7, 12288, v7
    v_mul_u32_u24 v5, 384, v5
    v_lshl_add_u32 v5, v6, 4, v5
    v_add_u32 v7, 63808, v7
    v_add_u32 v5, v5, v7
    v_subrev_u32 v6, 1, v6
    v_and_b32 v32, 0x3f803f80, v6
    v_mov_b32 v33, v32
    v_mov_b32 v34, v32
    v_mov_b32 v35, v32
    v_cmp_gt_u32 vcc, 192, v4
    s_and_saveexec_b64 s[94:95], vcc
    s_cbranch_execz p2b_noinit
    ds_write_b128 v5, v[32:35]
p2b_noinit:
    s_mov_b64 exec, -1
    s_add_u32 s38, s25, 5505024
    s_add_u32 s54, s22, s32
    s_add_u32 s54, s54, 2752512
    s_add_u32 s55, s54, 32768
    s_add_u32 s56, s23, s32
    s_and_b32 s56, s56, 0xfffffff0
    s_add_u32 s56, s56, 2752512
    s_mov_b32 s40, 51200
p2_hmx:
    s_mov_b32 s40, 51200
    s_mov_b32 s19, s43
    s_add_u32 s41, s40, s32
    s_add_u32 s42, s40, s33
    s_lshl_b32 s96, s19, 12
    s_mul_i32 s97, s19, 10240
    s_add_u32 s97, s97, s38
    s_add_u32 m0, s41, 0
    s_add_u32 s98, s54, s96
    s_mov_b64 exec, -1
    buffer_load_dwordx4 v16, s[12:15], s98 offen sc1 lds
    s_add_u32 m0, s42, 0
    s_mov_b64 exec, s[26:27]
    buffer_load_dwordx4 v17, s[12:15], s97 offen sc1 lds
    s_add_u32 m0, s41, 4096
    s_add_u32 s98, s55, s96
    s_mov_b64 exec, -1
    buffer_load_dwordx4 v16, s[12:15], s98 offen sc1 lds
    s_add_u32 m0, s42, 1024
    s_mov_b64 exec, s[28:29]
    buffer_load_dwordx4 v18, s[12:15], s97 offen sc1 lds
    s_add_u32 m0, s41, 8192
    s_add_u32 s98, s56, s96
    s_mov_b64 exec, -1
    buffer_load_dwordx4 v16, s[12:15], s98 offen sc1 lds
    s_add_u32 m0, s42, 2048
    s_mov_b64 exec, s[30:31]
    buffer_load_dwordx4 v19, s[12:15], s97 offen sc1 lds
    s_mov_b64 exec, -1
    s_add_u32 s40, s40, 24576
    s_cmp_eq_u32 s40, 124928
    s_cselect_b32 s40, 51200, s40
    s_waitcnt vmcnt(0) lgkmcnt(0)
    s_barrier
    s_barrier
    s_add_u32 s43, s43, 1
    s_cmp_lt_u32 s43, 8
    s_cbranch_scc1 p2_hmx
    s_add_u32 s38, s25, 5505024
    s_add_u32 s54, s22, s32
    s_add_u32 s54, s54, 2752512
    s_add_u32 s55, s54, 32768
    s_add_u32 s56, s23, s32
    s_and_b32 s56, s56, 0xfffffff0
    s_add_u32 s56, s56, 2752512
    s_mov_b32 s40, 51200
    s_mov_b32 s19, 0
    s_add_u32 s41, s40, s32
    s_add_u32 s42, s40, s33
    s_lshl_b32 s96, s19, 12
    s_mul_i32 s97, s19, 10240
    s_add_u32 s97, s97, s38
    s_add_u32 m0, s41, 0
    s_add_u32 s98, s54, s96
    s_mov_b64 exec, -1
    buffer_load_dwordx4 v16, s[12:15], s98 offen sc1 lds
    s_add_u32 m0, s42, 0
    s_mov_b64 exec, s[26:27]
    buffer_load_dwordx4 v17, s[12:15], s97 offen sc1 lds
    s_add_u32 m0, s41, 4096
    s_add_u32 s98, s55, s96
    s_mov_b64 exec, -1
    buffer_load_dwordx4 v16, s[12:15], s98 offen sc1 lds
    s_add_u32 m0, s42, 1024
    s_mov_b64 exec, s[28:29]
    buffer_load_dwordx4 v18, s[12:15], s97 offen sc1 lds
    s_add_u32 m0, s41, 8192
    s_add_u32 s98, s56, s96
    s_mov_b64 exec, -1
    buffer_load_dwordx4 v16, s[12:15], s98 offen sc1 lds
    s_add_u32 m0, s42, 2048
    s_mov_b64 exec, s[30:31]
    buffer_load_dwordx4 v19, s[12:15], s97 offen sc1 lds
    s_mov_b64 exec, -1
    s_add_u32 s40, s40, 24576
    s_cmp_eq_u32 s40, 124928
    s_cselect_b32 s40, 51200, s40
    s_mov_b32 s19, 1
    s_add_u32 s41, s40, s32
    s_add_u32 s42, s40, s33
    s_lshl_b32 s96, s19, 12
    s_mul_i32 s97, s19, 10240
    s_add_u32 s97, s97, s38
    s_add_u32 m0, s41, 0
    s_add_u32 s98, s54, s96
    s_mov_b64 exec, -1
    buffer_load_dwordx4 v16, s[12:15], s98 offen sc1 lds
    s_add_u32 m0, s42, 0
    s_mov_b64 exec, s[26:27]
    buffer_load_dwordx4 v17, s[12:15], s97 offen sc1 lds
    s_add_u32 m0, s41, 4096
    s_add_u32 s98, s55, s96
    s_mov_b64 exec, -1
    buffer_load_dwordx4 v16, s[12:15], s98 offen sc1 lds
    s_add_u32 m0, s42, 1024
    s_mov_b64 exec, s[28:29]
    buffer_load_dwordx4 v18, s[12:15], s97 offen sc1 lds
    s_add_u32 m0, s41, 8192
    s_add_u32 s98, s56, s96
    s_mov_b64 exec, -1
    buffer_load_dwordx4 v16, s[12:15], s98 offen sc1 lds
    s_add_u32 m0, s42, 2048
    s_mov_b64 exec, s[30:31]
    buffer_load_dwordx4 v19, s[12:15], s97 offen sc1 lds
    s_mov_b64 exec, -1
    s_add_u32 s40, s40, 24576
    s_cmp_eq_u32 s40, 124928
    s_cselect_b32 s40, 51200, s40
    s_mov_b32 s89, 3
    s_add_u32 s44, s45, 16
    s_waitcnt vmcnt(6)
    s_barrier
    s_mov_b32 s43, 0
    s_waitcnt vmcnt(0)
    s_branch p2_hloop
.section .rodata,"a"
.p2align 6
.amdhsa_kernel concat_heads__mha_block__linear_attn_block__prompt_kernel
  .amdhsa_next_free_vgpr 256
  .amdhsa_next_free_sgpr 102
  .amdhsa_accum_offset 256
  .amdhsa_group_segment_fixed_size 0
  .amdhsa_kernarg_size 72
  .amdhsa_user_sgpr_count 2
  .amdhsa_user_sgpr_kernarg_segment_ptr 1
  .amdhsa_system_sgpr_workgroup_id_x 1
.end_amdhsa_kernel
```
